```python
import torch

def _softmax(x, axis=-1):
    return torch.softmax(x, dim=axis)

def _gelu(x):
    return torch.nn.functional.gelu(x, approximate='tanh')

def _silu(x):
    return torch.nn.functional.silu(x)

def _sigmoid(x):
    return torch.sigmoid(x)

def _layernorm(x, axis=-1, eps=1e-05):
    m = x.mean(dim=axis, keepdim=True)
    v = x.var(dim=axis, keepdim=True, unbiased=False)
    return (x - m) / torch.sqrt(v + eps)

def _scatter_add(tgt, idx, src, axis=0):
    return tgt.clone().index_add_(axis, idx, src)

def _segment_sum(src, seg, n):
    out = torch.zeros((n,) + src.shape[1:], dtype=src.dtype)
    return out.index_add_(0, seg, src)

def _pad(x, pw):
    flat = tuple((v for pair in reversed(pw) for v in pair))
    return torch.nn.functional.pad(x, flat)
kernel_name = 'recurrent_scan__ssm_conv_h3__mixer_gmlp__prompt'

def setup_inputs():

    _w = lambda a: (lambda t: t.to(torch.bfloat16) if t.is_floating_point() else t)(torch.as_tensor(a))

    def _A_setup():
        B, S, D = (1, 2048, 576)
        ks = 4
        return {'q': _w((lambda *s: torch.randn(*s, dtype=torch.bfloat16) * 0.05)(B, S, D)), 'k': _w((lambda *s: torch.randn(*s, dtype=torch.bfloat16) * 0.2)(B, S, D)), 'v': _w((lambda *s: torch.randn(*s, dtype=torch.bfloat16) * 0.2)(B, S, D)), 'shift_k': _w((lambda *s: torch.randn(*s, dtype=torch.bfloat16) * 0.2)(D, ks) * 0.5), 'ssm_k': _w((lambda *s: torch.randn(*s, dtype=torch.bfloat16) * 0.2)(D, S) * (1.0 / S ** 0.5)), 'ssm_D': _w((lambda *s: torch.randn(*s, dtype=torch.bfloat16) * 0.2)(D))}
    _A_in = _A_setup()

    def _B_setup():
        B, S, D, F = (1, 2048, 576, 4608)
        Fh = F // 2
        return {'x': _w((lambda *s: torch.randn(*s, dtype=torch.bfloat16) * 0.05)(B, S, D)), 'w_in': _w((lambda *s: torch.randn(*s, dtype=torch.bfloat16) * 0.4)(D, 2 * Fh)), 'w_sp': _w(0.01 * (lambda *s: torch.randn(*s, dtype=torch.bfloat16) * 0.4)(S, S)), 'b_sp': _w(1.0 + 0.01 * (lambda *s: torch.randn(*s, dtype=torch.bfloat16) * 0.1)(S)), 'w_out': _w((lambda *s: torch.randn(*s, dtype=torch.bfloat16) * 0.1)(Fh, D))}
    _B_in = _B_setup()
    return {'A_q': _A_in['q'], 'A_k': _A_in['k'], 'A_v': _A_in['v'], 'A_shift_k': _A_in['shift_k'], 'A_ssm_k': _A_in['ssm_k'], 'A_ssm_D': _A_in['ssm_D'], 'B_x': _B_in['x'], 'B_w_in': _B_in['w_in'], 'B_w_sp': _B_in['w_sp'], 'B_b_sp': _B_in['b_sp'], 'B_w_out': _B_in['w_out']}

def reference(A_q, A_k, A_v, A_shift_k, A_ssm_k, A_ssm_D, B_x, B_w_in, B_w_sp, B_b_sp, B_w_out):

    def _A_ref(q, k, v, shift_k, ssm_k, ssm_D):
        B, S, D = q.shape
        ks = shift_k.shape[-1]
        k_pad = _pad(k, ((0, 0), (ks - 1, 0), (0, 0)))
        k_shift = torch.zeros_like(k)
        for t in range(ks):
            k_shift = k_shift + k_pad[:, t:t + S, :] * shift_k[:, ks - 1 - t][None, None, :]
        kv = k_shift * v
        L = 2 * S
        kv_pad = _pad(kv, ((0, 0), (0, S), (0, 0)))
        kf_pad = _pad(ssm_k, ((0, 0), (0, S)))
        kv_f = (lambda x, axes=(-2, -1): torch.fft.rfft2(x.float(), dim=axes))(kv_pad[:, None, :, :], axes=(1, 2))
        kf_f = (lambda x, axes=(-2, -1): torch.fft.rfft2(x.float(), dim=axes))(kf_pad[:, None, :], axes=(1, 2))
        kf_f = (lambda x, *d: x.permute(*d))(kf_f, 1, 2, 0)
        y_f = kv_f * kf_f[None, :, :, :]
        y = (lambda x, s, axes=(-2, -1): torch.fft.irfft2(x, s=s, dim=axes).to(torch.bfloat16))(y_f, (1, L), axes=(1, 2))[:, 0, :S, :]
        y = y + kv * ssm_D[None, None, :]
        return q * y

    def _B_ref(x, w_in, w_sp, b_sp, w_out):
        B, S, D = x.shape
        F = w_in.shape[-1]
        Fh = F // 2
        z = _gelu(torch.einsum('bsd,df->bsf', x, w_in))
        z1 = z[..., :Fh].clone()
        z2 = _layernorm(z[..., Fh:], axis=-1)
        g = torch.einsum('ts,bsf->btf', w_sp, z2) + b_sp[None, :, None]
        return torch.einsum('bsf,fd->bsd', z1 * g, w_out)
    x = A_q
    xn = _layernorm(x, axis=-1)
    s = _A_ref(xn, A_k, A_v, A_shift_k, A_ssm_k, A_ssm_D)
    g = _silu(_B_ref(xn, B_w_in, B_w_sp, B_b_sp, B_w_out))
    return x + s * g
```

```asm
; @launch kernel=k1_kernel grid=(256,1,1) block=(512,1,1) lds=163840
.amdgcn_target "amdgcn-amd-amdhsa--gfx950"
.text
.globl k1_kernel
.p2align 8
.type k1_kernel,@function
k1_kernel:
    s_load_dwordx2 s[80:81], s[0:1], 0
    s_load_dwordx2 s[4:5], s[0:1], 56
    s_load_dwordx2 s[6:7], s[0:1], 104
    s_load_dwordx2 s[18:19], s[0:1], 96
    s_cmp_ge_u32 s2, 256
    s_cbranch_scc1 k1_kernel_end
    v_lshrrev_b32 v1, 6, v0
    v_and_b32 v2, 63, v0
    v_readfirstlane_b32 s3, v1
    s_and_b32 s20, s2, 7
    s_lshr_b32 s21, s2, 3
    s_and_b32 s22, s20, 1
    s_lshl_b32 s22, s22, 3
    s_and_b32 s23, s21, 7
    s_add_u32 s22, s22, s23
    s_lshr_b32 s23, s20, 1
    s_lshl_b32 s23, s23, 2
    s_lshr_b32 s24, s21, 3
    s_add_u32 s23, s23, s24
    s_lshr_b32 s98, s3, 2
    s_mov_b32 s99, 0
    s_and_b32 s3, s3, 3
    s_lshr_b32 s24, s3, 1
    s_and_b32 s25, s3, 1
    v_and_b32 v3, 15, v2
    s_cmp_eq_u32 s98, 0
    s_cbranch_scc1 k1_kernel_A0
    s_setprio 3
    v_lshrrev_b32 v5, 3, v2
    v_and_b32 v4, 7, v2
    s_lshl_b32 s36, s3, 5
    v_add_u32 v5, s36, v5
    v_lshrrev_b32 v7, 4, v2
    v_xor_b32 v7, v7, v4
    v_mul_u32_u24 v6, 1152, v5
    v_lshl_add_u32 v204, v7, 4, v6
    v_xor_b32 v205, 64, v204
    v_add_u32 v205, 8192, v205
    v_add_u32 v206, 16384, v204
    v_add_u32 v207, 16384, v205
    s_lshl_b32 s84, s3, 12
    s_add_u32 s84, s84, 4096
    s_lshl_b32 s85, s3, 9
    s_add_u32 s85, s85, 36864
    s_waitcnt lgkmcnt(0)
    s_mov_b32 s28, s80
    s_and_b32 s29, s81, 0xffff
    s_mov_b32 s30, 0x240000
    s_mov_b32 s31, 0x00020000
    s_mov_b32 s8, s4
    s_and_b32 s9, s5, 0xffff
    s_mov_b32 s10, 0x510000
    s_mov_b32 s11, 0x00020000
    s_mov_b32 s12, s6
    s_and_b32 s13, s7, 0xffff
    s_mov_b32 s14, 0x10000000
    s_mov_b32 s15, 0x00020000
    s_mov_b32 s60, s18
    s_and_b32 s61, s19, 0xffff
    s_mov_b32 s62, 0x100
    s_mov_b32 s63, 0x00020000
    s_mul_i32 s82, s22, 147456
    s_mul_i32 s83, s23, 288
    s_add_u32 s86, s84, 0
    s_mov_b32 m0, s86
    s_add_u32 s87, s82, 0
    buffer_load_dwordx4 v204, s[28:31], s87 offen offset:0 lds
    buffer_load_dwordx4 v205, s[28:31], s87 offen offset:1024 lds
    buffer_load_dwordx4 v206, s[28:31], s87 offen offset:2048 lds
    buffer_load_dwordx4 v207, s[28:31], s87 offen offset:3072 lds
    s_lshl_b32 s36, s3, 8
    s_add_u32 s36, s36, 0
    v_add_u32 v6, s36, v2
    v_mul_u32_u24 v7, 3641, v6
    v_lshrrev_b32 v7, 16, v7
    v_mul_u32_u24 v8, 18, v7
    v_sub_u32 v8, v6, v8
    v_and_b32 v9, 35, v7
    v_bfe_u32 v6, v7, 2, 2
    v_lshl_add_u32 v9, v6, 3, v9
    v_bfe_u32 v6, v7, 4, 1
    v_lshl_add_u32 v9, v6, 2, v9
    v_mul_u32_u24 v9, 9216, v9
    v_lshl_add_u32 v208, v8, 4, v9
    s_lshl_b32 s36, s3, 8
    s_add_u32 s36, s36, 64
    v_add_u32 v6, s36, v2
    v_mul_u32_u24 v7, 3641, v6
    v_lshrrev_b32 v7, 16, v7
    v_mul_u32_u24 v8, 18, v7
    v_sub_u32 v8, v6, v8
    v_and_b32 v9, 35, v7
    v_bfe_u32 v6, v7, 2, 2
    v_lshl_add_u32 v9, v6, 3, v9
    v_bfe_u32 v6, v7, 4, 1
    v_lshl_add_u32 v9, v6, 2, v9
    v_mul_u32_u24 v9, 9216, v9
    v_lshl_add_u32 v209, v8, 4, v9
    v_subrev_u32 v209, 1024, v209
    s_lshl_b32 s36, s3, 8
    s_add_u32 s36, s36, 128
    v_add_u32 v6, s36, v2
    v_mul_u32_u24 v7, 3641, v6
    v_lshrrev_b32 v7, 16, v7
    v_mul_u32_u24 v8, 18, v7
    v_sub_u32 v8, v6, v8
    v_and_b32 v9, 35, v7
    v_bfe_u32 v6, v7, 2, 2
    v_lshl_add_u32 v9, v6, 3, v9
    v_bfe_u32 v6, v7, 4, 1
    v_lshl_add_u32 v9, v6, 2, v9
    v_mul_u32_u24 v9, 9216, v9
    v_lshl_add_u32 v210, v8, 4, v9
    v_subrev_u32 v210, 2048, v210
    s_lshl_b32 s36, s3, 8
    s_add_u32 s36, s36, 192
    v_add_u32 v6, s36, v2
    v_mul_u32_u24 v7, 3641, v6
    v_lshrrev_b32 v7, 16, v7
    v_mul_u32_u24 v8, 18, v7
    v_sub_u32 v8, v6, v8
    v_and_b32 v9, 35, v7
    v_bfe_u32 v6, v7, 2, 2
    v_lshl_add_u32 v9, v6, 3, v9
    v_bfe_u32 v6, v7, 4, 1
    v_lshl_add_u32 v9, v6, 2, v9
    v_mul_u32_u24 v9, 9216, v9
    v_lshl_add_u32 v211, v8, 4, v9
    v_subrev_u32 v211, 3072, v211
    s_lshl_b32 s36, s3, 5
    s_add_u32 s36, s36, 1024
    v_add_u32 v6, s36, v2
    v_mul_u32_u24 v7, 3641, v6
    v_lshrrev_b32 v7, 16, v7
    v_mul_u32_u24 v8, 18, v7
    v_sub_u32 v8, v6, v8
    v_and_b32 v9, 35, v7
    v_bfe_u32 v6, v7, 2, 2
    v_lshl_add_u32 v9, v6, 3, v9
    v_bfe_u32 v6, v7, 4, 1
    v_lshl_add_u32 v9, v6, 2, v9
    v_mul_u32_u24 v9, 9216, v9
    v_lshl_add_u32 v212, v8, 4, v9
    s_add_u32 s86, s84, 16384
    s_mov_b32 m0, s86
    s_add_u32 s87, s83, 4608
    buffer_load_dwordx4 v208, s[8:11], s87 offen offset:0 lds
    buffer_load_dwordx4 v209, s[8:11], s87 offen offset:1024 lds
    buffer_load_dwordx4 v210, s[8:11], s87 offen offset:2048 lds
    buffer_load_dwordx4 v211, s[8:11], s87 offen offset:3072 lds
    s_add_u32 s86, s85, 0
    s_mov_b32 m0, s86
    s_mov_b64 exec, 0xffffffff
    buffer_load_dwordx4 v212, s[8:11], s87 offen lds
    s_mov_b64 exec, -1
    s_add_u32 s86, s84, 34816
    s_mov_b32 m0, s86
    s_add_u32 s87, s82, 128
    buffer_load_dwordx4 v204, s[28:31], s87 offen offset:0 lds
    buffer_load_dwordx4 v205, s[28:31], s87 offen offset:1024 lds
    buffer_load_dwordx4 v206, s[28:31], s87 offen offset:2048 lds
    buffer_load_dwordx4 v207, s[28:31], s87 offen offset:3072 lds
    s_add_u32 s86, s84, 51200
    s_mov_b32 m0, s86
    s_add_u32 s87, s83, 594432
    buffer_load_dwordx4 v208, s[8:11], s87 offen offset:0 lds
    buffer_load_dwordx4 v209, s[8:11], s87 offen offset:1024 lds
    buffer_load_dwordx4 v210, s[8:11], s87 offen offset:2048 lds
    buffer_load_dwordx4 v211, s[8:11], s87 offen offset:3072 lds
    s_add_u32 s86, s85, 34816
    s_mov_b32 m0, s86
    s_mov_b64 exec, 0xffffffff
    buffer_load_dwordx4 v212, s[8:11], s87 offen lds
    s_mov_b64 exec, -1
    s_add_u32 s86, s84, 69632
    s_mov_b32 m0, s86
    s_add_u32 s87, s82, 256
    buffer_load_dwordx4 v204, s[28:31], s87 offen offset:0 lds
    buffer_load_dwordx4 v205, s[28:31], s87 offen offset:1024 lds
    buffer_load_dwordx4 v206, s[28:31], s87 offen offset:2048 lds
    buffer_load_dwordx4 v207, s[28:31], s87 offen offset:3072 lds
    s_add_u32 s86, s84, 86016
    s_mov_b32 m0, s86
    s_add_u32 s87, s83, 1184256
    buffer_load_dwordx4 v208, s[8:11], s87 offen offset:0 lds
    buffer_load_dwordx4 v209, s[8:11], s87 offen offset:1024 lds
    buffer_load_dwordx4 v210, s[8:11], s87 offen offset:2048 lds
    buffer_load_dwordx4 v211, s[8:11], s87 offen offset:3072 lds
    s_add_u32 s86, s85, 69632
    s_mov_b32 m0, s86
    s_mov_b64 exec, 0xffffffff
    buffer_load_dwordx4 v212, s[8:11], s87 offen lds
    s_mov_b64 exec, -1
    s_add_u32 s86, s84, 104448
    s_mov_b32 m0, s86
    s_add_u32 s87, s82, 384
    buffer_load_dwordx4 v204, s[28:31], s87 offen offset:0 lds
    buffer_load_dwordx4 v205, s[28:31], s87 offen offset:1024 lds
    buffer_load_dwordx4 v206, s[28:31], s87 offen offset:2048 lds
    buffer_load_dwordx4 v207, s[28:31], s87 offen offset:3072 lds
    s_add_u32 s86, s84, 120832
    s_mov_b32 m0, s86
    s_add_u32 s87, s83, 1774080
    buffer_load_dwordx4 v208, s[8:11], s87 offen offset:0 lds
    buffer_load_dwordx4 v209, s[8:11], s87 offen offset:1024 lds
    buffer_load_dwordx4 v210, s[8:11], s87 offen offset:2048 lds
    buffer_load_dwordx4 v211, s[8:11], s87 offen offset:3072 lds
    s_add_u32 s86, s85, 104448
    s_mov_b32 m0, s86
    s_mov_b64 exec, 0xffffffff
    buffer_load_dwordx4 v212, s[8:11], s87 offen lds
    s_mov_b64 exec, -1
    s_add_u32 s3, s3, 4
    s_sub_u32 s3, s3, 4
    s_load_dwordx4 s[64:67], s[0:1], 8
    s_load_dwordx2 s[76:77], s[0:1], 24
    v_lshrrev_b32 v10, 4, v2
    v_lshrrev_b32 v11, 1, v3
    v_xor_b32 v10, v10, v11
    v_lshlrev_b32 v10, 4, v10
    v_lshl_add_u32 v10, v3, 7, v10
    s_lshl_b32 s26, s24, 13
    s_add_u32 s26, s26, 4096
    v_add_u32 v10, s26, v10
    s_lshl_b32 s26, s25, 12
    v_add_u32 v88, s26, v10
    s_xor_b32 s26, s26, 4096
    v_add_u32 v90, s26, v10
    v_xor_b32 v89, 64, v88
    v_xor_b32 v91, 64, v90
    v_lshrrev_b32 v10, 2, v2
    v_mul_u32_u24 v10, 288, v10
    v_and_b32 v11, 3, v2
    v_lshl_add_u32 v10, v11, 3, v10
    v_add_u32 v10, 20480, v10
    s_mul_i32 s26, s25, 160
    v_add_u32 v92, s26, v10
    v_add_u32 v93, 128, v10
    v_mov_b32 v128, 0
    v_mov_b32 v129, 0
    v_mov_b32 v130, 0
    v_mov_b32 v131, 0
    v_mov_b32 v132, 0
    v_mov_b32 v133, 0
    v_mov_b32 v134, 0
    v_mov_b32 v135, 0
    v_mov_b32 v136, 0
    v_mov_b32 v137, 0
    v_mov_b32 v138, 0
    v_mov_b32 v139, 0
    v_mov_b32 v140, 0
    v_mov_b32 v141, 0
    v_mov_b32 v142, 0
    v_mov_b32 v143, 0
    v_mov_b32 v144, 0
    v_mov_b32 v145, 0
    v_mov_b32 v146, 0
    v_mov_b32 v147, 0
    v_mov_b32 v148, 0
    v_mov_b32 v149, 0
    v_mov_b32 v150, 0
    v_mov_b32 v151, 0
    v_mov_b32 v152, 0
    v_mov_b32 v153, 0
    v_mov_b32 v154, 0
    v_mov_b32 v155, 0
    v_mov_b32 v156, 0
    v_mov_b32 v157, 0
    v_mov_b32 v158, 0
    v_mov_b32 v159, 0
    v_mov_b32 v160, 0
    v_mov_b32 v161, 0
    v_mov_b32 v162, 0
    v_mov_b32 v163, 0
    v_mov_b32 v164, 0
    v_mov_b32 v165, 0
    v_mov_b32 v166, 0
    v_mov_b32 v167, 0
    v_mov_b32 v168, 0
    v_mov_b32 v169, 0
    v_mov_b32 v170, 0
    v_mov_b32 v171, 0
    v_mov_b32 v172, 0
    v_mov_b32 v173, 0
    v_mov_b32 v174, 0
    v_mov_b32 v175, 0
    v_mov_b32 v176, 0
    v_mov_b32 v177, 0
    v_mov_b32 v178, 0
    v_mov_b32 v179, 0
    v_mov_b32 v180, 0
    v_mov_b32 v181, 0
    v_mov_b32 v182, 0
    v_mov_b32 v183, 0
    v_mov_b32 v184, 0
    v_mov_b32 v185, 0
    v_mov_b32 v186, 0
    v_mov_b32 v187, 0
    v_mov_b32 v188, 0
    v_mov_b32 v189, 0
    v_mov_b32 v190, 0
    v_mov_b32 v191, 0
    v_mov_b32 v192, 0
    v_mov_b32 v193, 0
    v_mov_b32 v194, 0
    v_mov_b32 v195, 0
    v_mov_b32 v196, 0
    v_mov_b32 v197, 0
    v_mov_b32 v198, 0
    v_mov_b32 v199, 0
    v_mov_b32 v216, 0
    v_mov_b32 v217, 0
    v_mov_b32 v218, 0
    v_mov_b32 v219, 0
    v_mov_b32 v220, 0
    v_mov_b32 v221, 0
    v_mov_b32 v222, 0
    v_mov_b32 v223, 0
    v_mov_b32 v224, 0
    v_mov_b32 v225, 0
    v_mov_b32 v226, 0
    v_mov_b32 v227, 0
    v_mov_b32 v228, 0
    v_mov_b32 v229, 0
    v_mov_b32 v230, 0
    v_mov_b32 v231, 0
    v_mov_b32 v232, 0
    v_mov_b32 v233, 0
    v_mov_b32 v234, 0
    v_mov_b32 v235, 0
    v_mov_b32 v236, 0x3f803f80
    v_mov_b32 v237, 0x3f803f80
    v_mov_b32 v238, 0x3f803f80
    v_mov_b32 v239, 0x3f803f80
    s_waitcnt lgkmcnt(0)
    s_mov_b32 s68, s66
    s_and_b32 s69, s67, 0xffff
    s_mov_b32 s70, 0x240000
    s_mov_b32 s71, 0x00020000
    s_mov_b32 s88, s64
    s_mov_b32 s89, s65
    s_mov_b32 s64, s88
    s_and_b32 s65, s89, 0xffff
    s_mov_b32 s66, 0x240000
    s_mov_b32 s67, 0x00020000
    s_mov_b32 s72, s76
    s_and_b32 s73, s77, 0xffff
    s_mov_b32 s74, 0x1200
    s_mov_b32 s75, 0x00020000
    v_mov_b32 v96, 0
    v_mov_b32 v97, 0
    v_mov_b32 v98, 0
    v_mov_b32 v99, 0
    v_mov_b32 v100, 0
    v_mov_b32 v101, 0
    v_mov_b32 v102, 0
    v_mov_b32 v103, 0
    v_mov_b32 v104, 0
    v_mov_b32 v105, 0
    v_mov_b32 v106, 0
    v_mov_b32 v107, 0
    v_mov_b32 v108, 0
    v_mov_b32 v109, 0
    v_mov_b32 v110, 0
    v_mov_b32 v111, 0
    v_lshrrev_b32 v10, 4, v2
    v_lshrrev_b32 v11, 1, v3
    v_xor_b32 v10, v10, v11
    v_lshlrev_b32 v10, 4, v10
    v_lshl_add_u32 v10, v3, 7, v10
    v_add_u32 v12, s84, v10
    v_xor_b32 v13, 64, v12
    s_waitcnt vmcnt(27)
    s_barrier
    v_add_u32 v10, 0, v12
    v_add_u32 v11, 0, v13
    ds_read_b128 v[112:115], v10 offset:0
    ds_read_b128 v[116:119], v10 offset:2048
    ds_read_b128 v[120:123], v11 offset:0
    ds_read_b128 v[124:127], v11 offset:2048
    s_waitcnt vmcnt(18)
    s_barrier
    s_waitcnt lgkmcnt(0)
    v_mfma_f32_16x16x32_bf16 v[96:99], v[236:239], v[112:115], v[96:99]
    v_mfma_f32_16x16x32_bf16 v[104:107], v[112:115], v[112:115], v[104:107]
    v_mfma_f32_16x16x32_bf16 v[100:103], v[236:239], v[116:119], v[100:103]
    v_mfma_f32_16x16x32_bf16 v[108:111], v[116:119], v[116:119], v[108:111]
    v_mfma_f32_16x16x32_bf16 v[96:99], v[236:239], v[120:123], v[96:99]
    v_mfma_f32_16x16x32_bf16 v[104:107], v[120:123], v[120:123], v[104:107]
    v_mfma_f32_16x16x32_bf16 v[100:103], v[236:239], v[124:127], v[100:103]
    v_mfma_f32_16x16x32_bf16 v[108:111], v[124:127], v[124:127], v[108:111]
    v_add_u32 v10, 34816, v12
    v_add_u32 v11, 34816, v13
    ds_read_b128 v[112:115], v10 offset:0
    ds_read_b128 v[116:119], v10 offset:2048
    ds_read_b128 v[120:123], v11 offset:0
    ds_read_b128 v[124:127], v11 offset:2048
    s_waitcnt vmcnt(9)
    s_barrier
    s_waitcnt lgkmcnt(0)
    s_add_u32 s86, s84, 0
    s_mov_b32 m0, s86
    s_add_u32 s87, s82, 512
    buffer_load_dwordx4 v204, s[28:31], s87 offen offset:0 lds
    v_mfma_f32_16x16x32_bf16 v[96:99], v[236:239], v[112:115], v[96:99]
    buffer_load_dwordx4 v205, s[28:31], s87 offen offset:1024 lds
    v_mfma_f32_16x16x32_bf16 v[104:107], v[112:115], v[112:115], v[104:107]
    buffer_load_dwordx4 v206, s[28:31], s87 offen offset:2048 lds
    v_mfma_f32_16x16x32_bf16 v[100:103], v[236:239], v[116:119], v[100:103]
    buffer_load_dwordx4 v207, s[28:31], s87 offen offset:3072 lds
    v_mfma_f32_16x16x32_bf16 v[108:111], v[116:119], v[116:119], v[108:111]
    s_add_u32 s86, s84, 16384
    s_mov_b32 m0, s86
    s_add_u32 s87, s83, 2363904
    buffer_load_dwordx4 v208, s[8:11], s87 offen offset:0 lds
    v_mfma_f32_16x16x32_bf16 v[96:99], v[236:239], v[120:123], v[96:99]
    buffer_load_dwordx4 v209, s[8:11], s87 offen offset:1024 lds
    v_mfma_f32_16x16x32_bf16 v[104:107], v[120:123], v[120:123], v[104:107]
    buffer_load_dwordx4 v210, s[8:11], s87 offen offset:2048 lds
    v_mfma_f32_16x16x32_bf16 v[100:103], v[236:239], v[124:127], v[100:103]
    buffer_load_dwordx4 v211, s[8:11], s87 offen offset:3072 lds
    v_mfma_f32_16x16x32_bf16 v[108:111], v[124:127], v[124:127], v[108:111]
    s_add_u32 s86, s85, 0
    s_mov_b32 m0, s86
    s_mov_b64 exec, 0xffffffff
    buffer_load_dwordx4 v212, s[8:11], s87 offen lds
    s_mov_b64 exec, -1
    v_add_u32 v10, 69632, v12
    v_add_u32 v11, 69632, v13
    ds_read_b128 v[112:115], v10 offset:0
    ds_read_b128 v[116:119], v10 offset:2048
    ds_read_b128 v[120:123], v11 offset:0
    ds_read_b128 v[124:127], v11 offset:2048
    s_waitcnt vmcnt(9)
    s_barrier
    s_waitcnt lgkmcnt(0)
    s_add_u32 s86, s84, 34816
    s_mov_b32 m0, s86
    s_add_u32 s87, s82, 640
    buffer_load_dwordx4 v204, s[28:31], s87 offen offset:0 lds
    v_mfma_f32_16x16x32_bf16 v[96:99], v[236:239], v[112:115], v[96:99]
    buffer_load_dwordx4 v205, s[28:31], s87 offen offset:1024 lds
    v_mfma_f32_16x16x32_bf16 v[104:107], v[112:115], v[112:115], v[104:107]
    buffer_load_dwordx4 v206, s[28:31], s87 offen offset:2048 lds
    v_mfma_f32_16x16x32_bf16 v[100:103], v[236:239], v[116:119], v[100:103]
    buffer_load_dwordx4 v207, s[28:31], s87 offen offset:3072 lds
    v_mfma_f32_16x16x32_bf16 v[108:111], v[116:119], v[116:119], v[108:111]
    s_add_u32 s86, s84, 51200
    s_mov_b32 m0, s86
    s_add_u32 s87, s83, 2953728
    buffer_load_dwordx4 v208, s[8:11], s87 offen offset:0 lds
    v_mfma_f32_16x16x32_bf16 v[96:99], v[236:239], v[120:123], v[96:99]
    buffer_load_dwordx4 v209, s[8:11], s87 offen offset:1024 lds
    v_mfma_f32_16x16x32_bf16 v[104:107], v[120:123], v[120:123], v[104:107]
    buffer_load_dwordx4 v210, s[8:11], s87 offen offset:2048 lds
    v_mfma_f32_16x16x32_bf16 v[100:103], v[236:239], v[124:127], v[100:103]
    buffer_load_dwordx4 v211, s[8:11], s87 offen offset:3072 lds
    v_mfma_f32_16x16x32_bf16 v[108:111], v[124:127], v[124:127], v[108:111]
    s_add_u32 s86, s85, 34816
    s_mov_b32 m0, s86
    s_mov_b64 exec, 0xffffffff
    buffer_load_dwordx4 v212, s[8:11], s87 offen lds
    s_mov_b64 exec, -1
    v_add_u32 v10, 104448, v12
    v_add_u32 v11, 104448, v13
    ds_read_b128 v[112:115], v10 offset:0
    ds_read_b128 v[116:119], v10 offset:2048
    ds_read_b128 v[120:123], v11 offset:0
    ds_read_b128 v[124:127], v11 offset:2048
    s_waitcnt vmcnt(9)
    s_barrier
    s_waitcnt lgkmcnt(0)
    s_add_u32 s86, s84, 69632
    s_mov_b32 m0, s86
    s_add_u32 s87, s82, 768
    buffer_load_dwordx4 v204, s[28:31], s87 offen offset:0 lds
    v_mfma_f32_16x16x32_bf16 v[96:99], v[236:239], v[112:115], v[96:99]
    buffer_load_dwordx4 v205, s[28:31], s87 offen offset:1024 lds
    v_mfma_f32_16x16x32_bf16 v[104:107], v[112:115], v[112:115], v[104:107]
    buffer_load_dwordx4 v206, s[28:31], s87 offen offset:2048 lds
    v_mfma_f32_16x16x32_bf16 v[100:103], v[236:239], v[116:119], v[100:103]
    buffer_load_dwordx4 v207, s[28:31], s87 offen offset:3072 lds
    v_mfma_f32_16x16x32_bf16 v[108:111], v[116:119], v[116:119], v[108:111]
    s_add_u32 s86, s84, 86016
    s_mov_b32 m0, s86
    s_add_u32 s87, s83, 3543552
    buffer_load_dwordx4 v208, s[8:11], s87 offen offset:0 lds
    v_mfma_f32_16x16x32_bf16 v[96:99], v[236:239], v[120:123], v[96:99]
    buffer_load_dwordx4 v209, s[8:11], s87 offen offset:1024 lds
    v_mfma_f32_16x16x32_bf16 v[104:107], v[120:123], v[120:123], v[104:107]
    buffer_load_dwordx4 v210, s[8:11], s87 offen offset:2048 lds
    v_mfma_f32_16x16x32_bf16 v[100:103], v[236:239], v[124:127], v[100:103]
    buffer_load_dwordx4 v211, s[8:11], s87 offen offset:3072 lds
    v_mfma_f32_16x16x32_bf16 v[108:111], v[124:127], v[124:127], v[108:111]
    s_add_u32 s86, s85, 69632
    s_mov_b32 m0, s86
    s_mov_b64 exec, 0xffffffff
    buffer_load_dwordx4 v212, s[8:11], s87 offen lds
    s_mov_b64 exec, -1
    s_lshr_b32 s36, s2, 3
    s_mul_i32 s36, s36, 73728
    s_and_b32 s37, s2, 7
    s_mul_i32 s37, s37, 144
    s_add_u32 s36, s36, s37
    s_add_u32 s38, s3, 0
    s_sub_u32 s39, s38, 10
    s_cmp_lt_u32 s38, 10
    s_cselect_b32 s39, s38, s39
    s_cselect_b32 s40, 4294963840, 0
    s_lshl_b32 s37, s39, 6
    v_add_u32 v240, s37, v2
    v_mul_u32_u24 v241, 7282, v240
    v_lshrrev_b32 v241, 16, v241
    v_mul_u32_u24 v242, 9, v241
    v_sub_u32 v242, v240, v242
    v_mul_u32_u24 v241, 1152, v241
    v_lshl_add_u32 v241, v242, 4, v241
    s_add_u32 s40, s40, s36
    v_add_u32 v241, s40, v241
    s_lshl_b32 s37, s38, 10
    s_add_u32 s37, s37, 143360
    s_mov_b32 m0, s37
    s_nop 0
    buffer_load_dwordx4 v241, s[64:67], 0 offen lds
    s_add_u32 s38, s3, 4
    s_sub_u32 s39, s38, 10
    s_cmp_lt_u32 s38, 10
    s_cselect_b32 s39, s38, s39
    s_cselect_b32 s40, 4294963840, 0
    s_lshl_b32 s37, s39, 6
    v_add_u32 v240, s37, v2
    v_mul_u32_u24 v241, 7282, v240
    v_lshrrev_b32 v241, 16, v241
    v_mul_u32_u24 v242, 9, v241
    v_sub_u32 v242, v240, v242
    v_mul_u32_u24 v241, 1152, v241
    v_lshl_add_u32 v241, v242, 4, v241
    s_add_u32 s40, s40, s36
    v_add_u32 v241, s40, v241
    s_lshl_b32 s37, s38, 10
    s_add_u32 s37, s37, 143360
    s_mov_b32 m0, s37
    s_nop 0
    buffer_load_dwordx4 v241, s[64:67], 0 offen lds
    s_add_u32 s38, s3, 8
    s_sub_u32 s39, s38, 10
    s_cmp_lt_u32 s38, 10
    s_cselect_b32 s39, s38, s39
    s_cselect_b32 s40, 4294963840, 0
    s_lshl_b32 s37, s39, 6
    v_add_u32 v240, s37, v2
    v_mul_u32_u24 v241, 7282, v240
    v_lshrrev_b32 v241, 16, v241
    v_mul_u32_u24 v242, 9, v241
    v_sub_u32 v242, v240, v242
    v_mul_u32_u24 v241, 1152, v241
    v_lshl_add_u32 v241, v242, 4, v241
    s_add_u32 s40, s40, s36
    v_add_u32 v241, s40, v241
    s_lshl_b32 s37, s38, 10
    s_add_u32 s37, s37, 143360
    s_mov_b32 m0, s37
    s_cmp_lt_u32 s38, 10
    s_cbranch_scc1 k1_kernel_kd1
    buffer_load_dwordx4 v241, s[68:71], 0 offen lds
    s_branch k1_kernel_kd2
k1_kernel_kd1:
    buffer_load_dwordx4 v241, s[64:67], 0 offen lds
k1_kernel_kd2:
    s_add_u32 s38, s3, 12
    s_sub_u32 s39, s38, 10
    s_cmp_lt_u32 s38, 10
    s_cselect_b32 s39, s38, s39
    s_cselect_b32 s40, 4294963840, 0
    s_lshl_b32 s37, s39, 6
    v_add_u32 v240, s37, v2
    v_mul_u32_u24 v241, 7282, v240
    v_lshrrev_b32 v241, 16, v241
    v_mul_u32_u24 v242, 9, v241
    v_sub_u32 v242, v240, v242
    v_mul_u32_u24 v241, 1152, v241
    v_lshl_add_u32 v241, v242, 4, v241
    s_add_u32 s40, s40, s36
    v_add_u32 v241, s40, v241
    s_lshl_b32 s37, s38, 10
    s_add_u32 s37, s37, 143360
    s_mov_b32 m0, s37
    s_nop 0
    buffer_load_dwordx4 v241, s[68:71], 0 offen lds
    s_add_u32 s38, s3, 16
    s_min_u32 s38, s38, 18
    s_sub_u32 s39, s38, 10
    s_cmp_lt_u32 s38, 10
    s_cselect_b32 s39, s38, s39
    s_cselect_b32 s40, 4294963840, 0
    s_lshl_b32 s37, s39, 6
    v_add_u32 v240, s37, v2
    v_mul_u32_u24 v241, 7282, v240
    v_lshrrev_b32 v241, 16, v241
    v_mul_u32_u24 v242, 9, v241
    v_sub_u32 v242, v240, v242
    v_mul_u32_u24 v241, 1152, v241
    v_lshl_add_u32 v241, v242, 4, v241
    s_add_u32 s40, s40, s36
    v_add_u32 v241, s40, v241
    s_lshl_b32 s37, s38, 10
    s_add_u32 s37, s37, 143360
    s_mov_b32 m0, s37
    s_nop 0
    buffer_load_dwordx4 v241, s[68:71], 0 offen lds
    v_add_u32 v10, 0, v12
    v_add_u32 v11, 0, v13
    ds_read_b128 v[112:115], v10 offset:0
    ds_read_b128 v[116:119], v10 offset:2048
    ds_read_b128 v[120:123], v11 offset:0
    ds_read_b128 v[124:127], v11 offset:2048
    s_waitcnt vmcnt(14)
    s_barrier
    s_waitcnt lgkmcnt(0)
    s_add_u32 s86, s84, 104448
    s_mov_b32 m0, s86
    s_add_u32 s87, s82, 896
    buffer_load_dwordx4 v204, s[28:31], s87 offen offset:0 lds
    v_mfma_f32_16x16x32_bf16 v[96:99], v[236:239], v[112:115], v[96:99]
    buffer_load_dwordx4 v205, s[28:31], s87 offen offset:1024 lds
    v_mfma_f32_16x16x32_bf16 v[104:107], v[112:115], v[112:115], v[104:107]
    buffer_load_dwordx4 v206, s[28:31], s87 offen offset:2048 lds
    v_mfma_f32_16x16x32_bf16 v[100:103], v[236:239], v[116:119], v[100:103]
    buffer_load_dwordx4 v207, s[28:31], s87 offen offset:3072 lds
    v_mfma_f32_16x16x32_bf16 v[108:111], v[116:119], v[116:119], v[108:111]
    s_add_u32 s86, s84, 120832
    s_mov_b32 m0, s86
    s_add_u32 s87, s83, 4133376
    buffer_load_dwordx4 v208, s[8:11], s87 offen offset:0 lds
    v_mfma_f32_16x16x32_bf16 v[96:99], v[236:239], v[120:123], v[96:99]
    buffer_load_dwordx4 v209, s[8:11], s87 offen offset:1024 lds
    v_mfma_f32_16x16x32_bf16 v[104:107], v[120:123], v[120:123], v[104:107]
    buffer_load_dwordx4 v210, s[8:11], s87 offen offset:2048 lds
    v_mfma_f32_16x16x32_bf16 v[100:103], v[236:239], v[124:127], v[100:103]
    buffer_load_dwordx4 v211, s[8:11], s87 offen offset:3072 lds
    v_mfma_f32_16x16x32_bf16 v[108:111], v[124:127], v[124:127], v[108:111]
    s_add_u32 s86, s85, 104448
    s_mov_b32 m0, s86
    s_mov_b64 exec, 0xffffffff
    buffer_load_dwordx4 v212, s[8:11], s87 offen lds
    s_mov_b64 exec, -1
    v_add_u32 v10, 34816, v12
    v_add_u32 v11, 34816, v13
    ds_read_b128 v[112:115], v10 offset:0
    ds_read_b128 v[116:119], v10 offset:2048
    ds_read_b128 v[120:123], v11 offset:0
    ds_read_b128 v[124:127], v11 offset:2048
    s_waitcnt vmcnt(14)
    s_barrier
    s_waitcnt lgkmcnt(0)
    s_add_u32 s86, s84, 0
    s_mov_b32 m0, s86
    s_add_u32 s87, s82, 1024
    buffer_load_dwordx4 v204, s[28:31], s87 offen offset:0 lds
    v_mfma_f32_16x16x32_bf16 v[96:99], v[236:239], v[112:115], v[96:99]
    buffer_load_dwordx4 v205, s[28:31], s87 offen offset:1024 lds
    v_mfma_f32_16x16x32_bf16 v[104:107], v[112:115], v[112:115], v[104:107]
    buffer_load_dwordx4 v206, s[28:31], s87 offen offset:2048 lds
    v_mfma_f32_16x16x32_bf16 v[100:103], v[236:239], v[116:119], v[100:103]
    buffer_load_dwordx4 v207, s[28:31], s87 offen offset:3072 lds
    v_mfma_f32_16x16x32_bf16 v[108:111], v[116:119], v[116:119], v[108:111]
    s_add_u32 s86, s84, 16384
    s_mov_b32 m0, s86
    s_add_u32 s87, s83, 4723200
    buffer_load_dwordx4 v208, s[8:11], s87 offen offset:0 lds
    v_mfma_f32_16x16x32_bf16 v[96:99], v[236:239], v[120:123], v[96:99]
    buffer_load_dwordx4 v209, s[8:11], s87 offen offset:1024 lds
    v_mfma_f32_16x16x32_bf16 v[104:107], v[120:123], v[120:123], v[104:107]
    buffer_load_dwordx4 v210, s[8:11], s87 offen offset:2048 lds
    v_mfma_f32_16x16x32_bf16 v[100:103], v[236:239], v[124:127], v[100:103]
    buffer_load_dwordx4 v211, s[8:11], s87 offen offset:3072 lds
    v_mfma_f32_16x16x32_bf16 v[108:111], v[124:127], v[124:127], v[108:111]
    s_add_u32 s86, s85, 0
    s_mov_b32 m0, s86
    s_mov_b64 exec, 0xffffffff
    buffer_load_dwordx4 v212, s[8:11], s87 offen lds
    s_mov_b64 exec, -1
    v_add_u32 v10, 69632, v12
    v_add_u32 v11, 69632, v13
    ds_read_b128 v[112:115], v10 offset:0
    ds_read_b128 v[116:119], v10 offset:2048
    ds_read_b128 v[120:123], v11 offset:0
    ds_read_b128 v[124:127], v11 offset:2048
    s_waitcnt vmcnt(9)
    s_barrier
    s_waitcnt lgkmcnt(0)
    s_add_u32 s86, s84, 34816
    s_mov_b32 m0, s86
    s_add_u32 s87, s82, 0
    buffer_load_dwordx4 v204, s[28:31], s87 offen offset:0 lds
    v_mfma_f32_16x16x32_bf16 v[96:99], v[236:239], v[112:115], v[96:99]
    buffer_load_dwordx4 v205, s[28:31], s87 offen offset:1024 lds
    v_mfma_f32_16x16x32_bf16 v[104:107], v[112:115], v[112:115], v[104:107]
    buffer_load_dwordx4 v206, s[28:31], s87 offen offset:2048 lds
    v_mfma_f32_16x16x32_bf16 v[100:103], v[236:239], v[116:119], v[100:103]
    buffer_load_dwordx4 v207, s[28:31], s87 offen offset:3072 lds
    v_mfma_f32_16x16x32_bf16 v[108:111], v[116:119], v[116:119], v[108:111]
    s_add_u32 s86, s84, 51200
    s_mov_b32 m0, s86
    s_add_u32 s87, s83, 0
    buffer_load_dwordx4 v208, s[8:11], s87 offen offset:0 lds
    v_mfma_f32_16x16x32_bf16 v[96:99], v[236:239], v[120:123], v[96:99]
    buffer_load_dwordx4 v209, s[8:11], s87 offen offset:1024 lds
    v_mfma_f32_16x16x32_bf16 v[104:107], v[120:123], v[120:123], v[104:107]
    buffer_load_dwordx4 v210, s[8:11], s87 offen offset:2048 lds
    v_mfma_f32_16x16x32_bf16 v[100:103], v[236:239], v[124:127], v[100:103]
    buffer_load_dwordx4 v211, s[8:11], s87 offen offset:3072 lds
    v_mfma_f32_16x16x32_bf16 v[108:111], v[124:127], v[124:127], v[108:111]
    s_add_u32 s86, s85, 34816
    s_mov_b32 m0, s86
    s_mov_b64 exec, 0xffffffff
    buffer_load_dwordx4 v212, s[8:11], s87 offen lds
    s_mov_b64 exec, -1
    v_add_u32 v10, 104448, v12
    v_add_u32 v11, 104448, v13
    ds_read_b128 v[112:115], v10 offset:0
    ds_read_b128 v[116:119], v10 offset:2048
    ds_read_b128 v[120:123], v11 offset:0
    ds_read_b128 v[124:127], v11 offset:2048
    s_waitcnt vmcnt(9)
    s_barrier
    s_waitcnt lgkmcnt(0)
    s_add_u32 s86, s84, 69632
    s_mov_b32 m0, s86
    s_add_u32 s87, s82, 128
    buffer_load_dwordx4 v204, s[28:31], s87 offen offset:0 lds
    v_mfma_f32_16x16x32_bf16 v[96:99], v[236:239], v[112:115], v[96:99]
    buffer_load_dwordx4 v205, s[28:31], s87 offen offset:1024 lds
    v_mfma_f32_16x16x32_bf16 v[104:107], v[112:115], v[112:115], v[104:107]
    buffer_load_dwordx4 v206, s[28:31], s87 offen offset:2048 lds
    v_mfma_f32_16x16x32_bf16 v[100:103], v[236:239], v[116:119], v[100:103]
    buffer_load_dwordx4 v207, s[28:31], s87 offen offset:3072 lds
    v_mfma_f32_16x16x32_bf16 v[108:111], v[116:119], v[116:119], v[108:111]
    s_add_u32 s86, s84, 86016
    s_mov_b32 m0, s86
    s_add_u32 s87, s83, 589824
    buffer_load_dwordx4 v208, s[8:11], s87 offen offset:0 lds
    v_mfma_f32_16x16x32_bf16 v[96:99], v[236:239], v[120:123], v[96:99]
    buffer_load_dwordx4 v209, s[8:11], s87 offen offset:1024 lds
    v_mfma_f32_16x16x32_bf16 v[104:107], v[120:123], v[120:123], v[104:107]
    buffer_load_dwordx4 v210, s[8:11], s87 offen offset:2048 lds
    v_mfma_f32_16x16x32_bf16 v[100:103], v[236:239], v[124:127], v[100:103]
    buffer_load_dwordx4 v211, s[8:11], s87 offen offset:3072 lds
    v_mfma_f32_16x16x32_bf16 v[108:111], v[124:127], v[124:127], v[108:111]
    s_add_u32 s86, s85, 69632
    s_mov_b32 m0, s86
    s_mov_b64 exec, 0xffffffff
    buffer_load_dwordx4 v212, s[8:11], s87 offen lds
    s_mov_b64 exec, -1
    v_add_u32 v10, 0, v12
    v_add_u32 v11, 0, v13
    ds_read_b128 v[112:115], v10 offset:0
    ds_read_b128 v[116:119], v10 offset:2048
    ds_read_b128 v[120:123], v11 offset:0
    ds_read_b128 v[124:127], v11 offset:2048
    s_waitcnt vmcnt(9)
    s_barrier
    s_waitcnt lgkmcnt(0)
    s_add_u32 s86, s84, 104448
    s_mov_b32 m0, s86
    s_add_u32 s87, s82, 256
    buffer_load_dwordx4 v204, s[28:31], s87 offen offset:0 lds
    v_mfma_f32_16x16x32_bf16 v[96:99], v[236:239], v[112:115], v[96:99]
    buffer_load_dwordx4 v205, s[28:31], s87 offen offset:1024 lds
    v_mfma_f32_16x16x32_bf16 v[104:107], v[112:115], v[112:115], v[104:107]
    buffer_load_dwordx4 v206, s[28:31], s87 offen offset:2048 lds
    v_mfma_f32_16x16x32_bf16 v[100:103], v[236:239], v[116:119], v[100:103]
    buffer_load_dwordx4 v207, s[28:31], s87 offen offset:3072 lds
    v_mfma_f32_16x16x32_bf16 v[108:111], v[116:119], v[116:119], v[108:111]
    s_add_u32 s86, s84, 120832
    s_mov_b32 m0, s86
    s_add_u32 s87, s83, 1179648
    buffer_load_dwordx4 v208, s[8:11], s87 offen offset:0 lds
    v_mfma_f32_16x16x32_bf16 v[96:99], v[236:239], v[120:123], v[96:99]
    buffer_load_dwordx4 v209, s[8:11], s87 offen offset:1024 lds
    v_mfma_f32_16x16x32_bf16 v[104:107], v[120:123], v[120:123], v[104:107]
    buffer_load_dwordx4 v210, s[8:11], s87 offen offset:2048 lds
    v_mfma_f32_16x16x32_bf16 v[100:103], v[236:239], v[124:127], v[100:103]
    buffer_load_dwordx4 v211, s[8:11], s87 offen offset:3072 lds
    v_mfma_f32_16x16x32_bf16 v[108:111], v[124:127], v[124:127], v[108:111]
    s_add_u32 s86, s85, 104448
    s_mov_b32 m0, s86
    s_mov_b64 exec, 0xffffffff
    buffer_load_dwordx4 v212, s[8:11], s87 offen lds
    s_mov_b64 exec, -1
    s_nop 7
    v_lshrrev_b32 v10, 4, v2
    v_lshrrev_b32 v11, 2, v3
    v_and_b32 v12, 3, v3
    v_cmp_eq_u32 vcc, 1, v12
    s_nop 1
    v_cndmask_b32 v104, v104, v105, vcc
    v_cmp_eq_u32 vcc, 2, v12
    s_nop 1
    v_cndmask_b32 v104, v104, v106, vcc
    v_cmp_eq_u32 vcc, 3, v12
    s_nop 1
    v_cndmask_b32 v104, v104, v107, vcc
    v_cmp_eq_u32 vcc, 1, v12
    s_nop 1
    v_cndmask_b32 v108, v108, v109, vcc
    v_cmp_eq_u32 vcc, 2, v12
    s_nop 1
    v_cndmask_b32 v108, v108, v110, vcc
    v_cmp_eq_u32 vcc, 3, v12
    s_nop 1
    v_cndmask_b32 v108, v108, v111, vcc
    v_mul_f32 v112, 0x3ae38e39, v96
    v_mul_f32 v113, 0x3ae38e39, v104
    v_fma_f32 v113, -v112, v112, v113
    v_max_f32 v113, 0, v113
    v_cvt_pk_bf16_f32 v120, v112, v113
    v_lshlrev_b32 v112, 16, v120
    v_and_b32 v113, 0xffff0000, v120
    v_add_f32 v113, 0x3727c5ac, v113
    v_cvt_pk_bf16_f32 v120, v113, v113
    v_lshlrev_b32 v113, 16, v120
    v_sqrt_f32 v113, v113
    s_nop 0
    v_cvt_pk_bf16_f32 v120, v113, v113
    v_lshlrev_b32 v113, 16, v120
    v_rcp_f32 v113, v113
    s_nop 0
    v_mov_b32 v117, v113
    v_sub_f32 v116, 0, v112
    v_mul_f32 v114, 0x3ae38e39, v100
    v_mul_f32 v115, 0x3ae38e39, v108
    v_fma_f32 v115, -v114, v114, v115
    v_max_f32 v115, 0, v115
    v_cvt_pk_bf16_f32 v120, v114, v115
    v_lshlrev_b32 v114, 16, v120
    v_and_b32 v115, 0xffff0000, v120
    v_add_f32 v115, 0x3727c5ac, v115
    v_cvt_pk_bf16_f32 v120, v115, v115
    v_lshlrev_b32 v115, 16, v120
    v_sqrt_f32 v115, v115
    s_nop 0
    v_cvt_pk_bf16_f32 v120, v115, v115
    v_lshlrev_b32 v115, 16, v120
    v_rcp_f32 v115, v115
    s_nop 0
    v_mov_b32 v119, v115
    v_sub_f32 v118, 0, v114
    s_lshl_b32 s35, s3, 8
    v_lshlrev_b32 v13, 3, v3
    v_add_u32 v12, s35, v13
    v_cmp_eq_u32 vcc, v10, v11
    s_and_saveexec_b64 s[36:37], vcc
    ds_write_b64 v12, v[116:117] offset:0
    ds_write_b64 v12, v[118:119] offset:128
    s_mov_b64 exec, s[36:37]
    s_cmp_lg_u32 s23, 0
    s_cbranch_scc1 k1_kernel_nost1
    s_lshl_b32 s35, s22, 7
    s_lshl_b32 s36, s3, 5
    s_add_u32 s35, s35, s36
    s_lshl_b32 s35, s35, 3
    s_add_u32 s35, s35, 0x2b00000
    v_mov_b32 v11, 0x7ffffff0
    v_cndmask_b32 v13, v11, v13, vcc
    buffer_store_dwordx2 v[112:113], v13, s[12:15], s35 offen offset:0 sc1
    buffer_store_dwordx2 v[114:115], v13, s[12:15], s35 offen offset:128 sc1
k1_kernel_nost1:
    v_and_b32 v0, 255, v0
    v_lshrrev_b32 v1, 3, v0
    v_and_b32 v10, 7, v0
    s_lshr_b32 s38, s2, 3
    s_lshl_b32 s38, s38, 6
    v_lshl_add_u32 v252, v10, 3, s38
    s_and_b32 s39, s2, 7
    s_mul_i32 s39, s39, 144
    v_lshl_add_u32 v253, v1, 2, s39
    v_lshlrev_b32 v11, 2, v253
    buffer_load_dwordx4 v[248:251], v11, s[72:75], 0 offen
    buffer_load_dwordx4 v[244:247], v11, s[72:75], 0 offen offset:512
    v_mul_u32_u24 v254, 1152, v10
    v_lshl_add_u32 v254, v1, 2, v254
    v_add_u32 v254, 143360, v254
    s_mov_b32 s41, 0
    s_mov_b32 s27, 34816
    v_add_u32 v4, s27, v88
    v_add_u32 v6, s27, v90
    v_add_u32 v5, s27, v89
    v_add_u32 v7, s27, v91
    v_add_u32 v8, s27, v92
    v_add_u32 v9, s27, v93
    s_mov_b32 s33, 0
    s_setprio 0
    s_waitcnt vmcnt(9) lgkmcnt(0)
    s_branch k1_kernel_mma
k1_kernel_A0:
    s_load_dwordx4 s[64:67], s[0:1], 8
    s_load_dwordx2 s[76:77], s[0:1], 24
    s_load_dwordx2 s[78:79], s[0:1], 64
    v_lshrrev_b32 v10, 4, v2
    v_lshrrev_b32 v11, 1, v3
    v_xor_b32 v10, v10, v11
    v_lshlrev_b32 v10, 4, v10
    v_lshl_add_u32 v10, v3, 7, v10
    s_lshl_b32 s26, s24, 13
    s_add_u32 s26, s26, 4096
    v_add_u32 v10, s26, v10
    s_lshl_b32 s26, s25, 12
    v_add_u32 v88, s26, v10
    s_xor_b32 s26, s26, 4096
    v_add_u32 v90, s26, v10
    v_xor_b32 v89, 64, v88
    v_xor_b32 v91, 64, v90
    v_lshrrev_b32 v10, 2, v2
    v_mul_u32_u24 v10, 288, v10
    v_and_b32 v11, 3, v2
    v_lshl_add_u32 v10, v11, 3, v10
    v_add_u32 v10, 20480, v10
    s_mul_i32 s26, s25, 160
    v_add_u32 v92, s26, v10
    v_add_u32 v93, 128, v10
    v_mov_b32 v128, 0
    v_mov_b32 v129, 0
    v_mov_b32 v130, 0
    v_mov_b32 v131, 0
    v_mov_b32 v132, 0
    v_mov_b32 v133, 0
    v_mov_b32 v134, 0
    v_mov_b32 v135, 0
    v_mov_b32 v136, 0
    v_mov_b32 v137, 0
    v_mov_b32 v138, 0
    v_mov_b32 v139, 0
    v_mov_b32 v140, 0
    v_mov_b32 v141, 0
    v_mov_b32 v142, 0
    v_mov_b32 v143, 0
    v_mov_b32 v144, 0
    v_mov_b32 v145, 0
    v_mov_b32 v146, 0
    v_mov_b32 v147, 0
    v_mov_b32 v148, 0
    v_mov_b32 v149, 0
    v_mov_b32 v150, 0
    v_mov_b32 v151, 0
    v_mov_b32 v152, 0
    v_mov_b32 v153, 0
    v_mov_b32 v154, 0
    v_mov_b32 v155, 0
    v_mov_b32 v156, 0
    v_mov_b32 v157, 0
    v_mov_b32 v158, 0
    v_mov_b32 v159, 0
    v_mov_b32 v160, 0
    v_mov_b32 v161, 0
    v_mov_b32 v162, 0
    v_mov_b32 v163, 0
    v_mov_b32 v164, 0
    v_mov_b32 v165, 0
    v_mov_b32 v166, 0
    v_mov_b32 v167, 0
    v_mov_b32 v168, 0
    v_mov_b32 v169, 0
    v_mov_b32 v170, 0
    v_mov_b32 v171, 0
    v_mov_b32 v172, 0
    v_mov_b32 v173, 0
    v_mov_b32 v174, 0
    v_mov_b32 v175, 0
    v_mov_b32 v176, 0
    v_mov_b32 v177, 0
    v_mov_b32 v178, 0
    v_mov_b32 v179, 0
    v_mov_b32 v180, 0
    v_mov_b32 v181, 0
    v_mov_b32 v182, 0
    v_mov_b32 v183, 0
    v_mov_b32 v184, 0
    v_mov_b32 v185, 0
    v_mov_b32 v186, 0
    v_mov_b32 v187, 0
    v_mov_b32 v188, 0
    v_mov_b32 v189, 0
    v_mov_b32 v190, 0
    v_mov_b32 v191, 0
    v_mov_b32 v192, 0
    v_mov_b32 v193, 0
    v_mov_b32 v194, 0
    v_mov_b32 v195, 0
    v_mov_b32 v196, 0
    v_mov_b32 v197, 0
    v_mov_b32 v198, 0
    v_mov_b32 v199, 0
    v_mov_b32 v216, 0
    v_mov_b32 v217, 0
    v_mov_b32 v218, 0
    v_mov_b32 v219, 0
    v_mov_b32 v220, 0
    v_mov_b32 v221, 0
    v_mov_b32 v222, 0
    v_mov_b32 v223, 0
    v_mov_b32 v224, 0
    v_mov_b32 v225, 0
    v_mov_b32 v226, 0
    v_mov_b32 v227, 0
    v_mov_b32 v228, 0
    v_mov_b32 v229, 0
    v_mov_b32 v230, 0
    v_mov_b32 v231, 0
    v_mov_b32 v232, 0
    v_mov_b32 v233, 0
    v_mov_b32 v234, 0
    v_mov_b32 v235, 0
    v_mov_b32 v236, 0x3f803f80
    v_mov_b32 v237, 0x3f803f80
    v_mov_b32 v238, 0x3f803f80
    v_mov_b32 v239, 0x3f803f80
    v_lshrrev_b32 v5, 3, v2
    v_and_b32 v4, 7, v2
    s_lshl_b32 s36, s3, 5
    v_add_u32 v5, s36, v5
    v_lshrrev_b32 v7, 4, v2
    v_xor_b32 v7, v7, v4
    v_mul_u32_u24 v6, 1152, v5
    v_lshl_add_u32 v204, v7, 4, v6
    v_xor_b32 v205, 64, v204
    v_add_u32 v205, 8192, v205
    v_add_u32 v206, 16384, v204
    v_add_u32 v207, 16384, v205
    s_lshl_b32 s84, s3, 12
    s_add_u32 s84, s84, 4096
    s_lshl_b32 s85, s3, 9
    s_add_u32 s85, s85, 36864
    s_lshl_b32 s36, s3, 8
    s_add_u32 s36, s36, 0
    v_add_u32 v6, s36, v2
    v_mul_u32_u24 v7, 3641, v6
    v_lshrrev_b32 v7, 16, v7
    v_mul_u32_u24 v8, 18, v7
    v_sub_u32 v8, v6, v8
    v_and_b32 v9, 35, v7
    v_bfe_u32 v6, v7, 2, 2
    v_lshl_add_u32 v9, v6, 3, v9
    v_bfe_u32 v6, v7, 4, 1
    v_lshl_add_u32 v9, v6, 2, v9
    v_mul_u32_u24 v9, 9216, v9
    v_lshl_add_u32 v208, v8, 4, v9
    s_lshl_b32 s36, s3, 8
    s_add_u32 s36, s36, 64
    v_add_u32 v6, s36, v2
    v_mul_u32_u24 v7, 3641, v6
    v_lshrrev_b32 v7, 16, v7
    v_mul_u32_u24 v8, 18, v7
    v_sub_u32 v8, v6, v8
    v_and_b32 v9, 35, v7
    v_bfe_u32 v6, v7, 2, 2
    v_lshl_add_u32 v9, v6, 3, v9
    v_bfe_u32 v6, v7, 4, 1
    v_lshl_add_u32 v9, v6, 2, v9
    v_mul_u32_u24 v9, 9216, v9
    v_lshl_add_u32 v209, v8, 4, v9
    v_subrev_u32 v209, 1024, v209
    s_lshl_b32 s36, s3, 8
    s_add_u32 s36, s36, 128
    v_add_u32 v6, s36, v2
    v_mul_u32_u24 v7, 3641, v6
    v_lshrrev_b32 v7, 16, v7
    v_mul_u32_u24 v8, 18, v7
    v_sub_u32 v8, v6, v8
    v_and_b32 v9, 35, v7
    v_bfe_u32 v6, v7, 2, 2
    v_lshl_add_u32 v9, v6, 3, v9
    v_bfe_u32 v6, v7, 4, 1
    v_lshl_add_u32 v9, v6, 2, v9
    v_mul_u32_u24 v9, 9216, v9
    v_lshl_add_u32 v210, v8, 4, v9
    v_subrev_u32 v210, 2048, v210
    s_lshl_b32 s36, s3, 8
    s_add_u32 s36, s36, 192
    v_add_u32 v6, s36, v2
    v_mul_u32_u24 v7, 3641, v6
    v_lshrrev_b32 v7, 16, v7
    v_mul_u32_u24 v8, 18, v7
    v_sub_u32 v8, v6, v8
    v_and_b32 v9, 35, v7
    v_bfe_u32 v6, v7, 2, 2
    v_lshl_add_u32 v9, v6, 3, v9
    v_bfe_u32 v6, v7, 4, 1
    v_lshl_add_u32 v9, v6, 2, v9
    v_mul_u32_u24 v9, 9216, v9
    v_lshl_add_u32 v211, v8, 4, v9
    v_subrev_u32 v211, 3072, v211
    s_lshl_b32 s36, s3, 5
    s_add_u32 s36, s36, 1024
    v_add_u32 v6, s36, v2
    v_mul_u32_u24 v7, 3641, v6
    v_lshrrev_b32 v7, 16, v7
    v_mul_u32_u24 v8, 18, v7
    v_sub_u32 v8, v6, v8
    v_and_b32 v9, 35, v7
    v_bfe_u32 v6, v7, 2, 2
    v_lshl_add_u32 v9, v6, 3, v9
    v_bfe_u32 v6, v7, 4, 1
    v_lshl_add_u32 v9, v6, 2, v9
    v_mul_u32_u24 v9, 9216, v9
    v_lshl_add_u32 v212, v8, 4, v9
    s_waitcnt lgkmcnt(0)
    s_mov_b32 s28, s80
    s_and_b32 s29, s81, 0xffff
    s_mov_b32 s30, 0x240000
    s_mov_b32 s31, 0x00020000
    s_mov_b32 s8, s4
    s_and_b32 s9, s5, 0xffff
    s_mov_b32 s10, 0x510000
    s_mov_b32 s11, 0x00020000
    s_mov_b32 s12, s6
    s_and_b32 s13, s7, 0xffff
    s_mov_b32 s14, 0x10000000
    s_mov_b32 s15, 0x00020000
    s_mov_b32 s60, s18
    s_and_b32 s61, s19, 0xffff
    s_mov_b32 s62, 0x100
    s_mov_b32 s63, 0x00020000
    s_mul_i32 s82, s22, 147456
    s_mul_i32 s83, s23, 288
    s_mov_b32 s68, s66
    s_and_b32 s69, s67, 0xffff
    s_mov_b32 s70, 0x240000
    s_mov_b32 s71, 0x00020000
    s_mov_b32 s88, s64
    s_mov_b32 s89, s65
    s_mov_b32 s64, s88
    s_and_b32 s65, s89, 0xffff
    s_mov_b32 s66, 0x240000
    s_mov_b32 s67, 0x00020000
    s_mov_b32 s72, s76
    s_and_b32 s73, s77, 0xffff
    s_mov_b32 s74, 0x1200
    s_mov_b32 s75, 0x00020000
    v_lshrrev_b32 v10, 4, v2
    s_lshl_b32 s36, s25, 1
    v_add_u32 v11, s36, v10
    v_and_b32 v11, 3, v11
    v_lshl_add_u32 v11, v11, 4, v3
    v_lshlrev_b32 v94, 3, v11
    s_lshl_b32 s59, s22, 15
    s_lshl_b32 s36, s24, 9
    s_add_u32 s59, s59, s36
    s_add_u32 s59, s59, 0x2a00000
    s_lshl_b32 s36, s23, 1
    s_add_u32 s36, s36, s25
    s_lshl_b32 s36, s36, 10
    s_add_u32 s58, s36, s59
    v_mov_b32 v12, 0
    v_mov_b32 v13, 0x80000000
    buffer_store_dwordx2 v[12:13], v94, s[12:15], s58 offen sc1
    s_lshl_b32 s36, s22, 4
    s_add_u32 s36, s36, s23
    s_lshl_b32 s36, s36, 8
    s_add_u32 s97, s36, 0x2d00000
    v_mov_b32 v10, 2048
    v_mov_b32 v12, 0
    v_mov_b32 v13, 0
    s_mov_b64 exec, 1
    buffer_store_dword v12, v12, s[12:15], s97 offen sc1
    buffer_store_dword v12, v12, s[12:15], s97 offen offset:128 sc1
    s_lshl_b32 s36, s2, 7
    s_add_u32 s37, s36, 0x2d20000
    s_add_u32 s36, s36, 0x2d30000
    buffer_store_dword v12, v12, s[12:15], s37 offen sc1
    buffer_store_dword v12, v12, s[12:15], s36 offen sc1
    s_mov_b64 exec, -1
    ds_write_b64 v10, v[12:13]
    ds_write_b64 v10, v[12:13] offset:8
    ds_write_b64 v10, v[12:13] offset:16
    ds_write_b64 v10, v[12:13] offset:24
    s_mov_b32 s27, 0
    v_add_u32 v4, s27, v88
    v_add_u32 v6, s27, v90
    v_add_u32 v5, s27, v89
    v_add_u32 v7, s27, v91
    v_add_u32 v8, s27, v92
    v_add_u32 v9, s27, v93
    s_mov_b32 s33, 0
    s_waitcnt lgkmcnt(0)
    s_barrier
k1_kernel_mma:
    ds_read_b128 v[16:19], v4 offset:0
    ds_read_b64_tr_b16 v[32:33], v8 offset:0
    ds_read_b64_tr_b16 v[34:35], v8 offset:4608
    ds_read_b128 v[20:23], v4 offset:2048
    ds_read_b128 v[24:27], v6 offset:0
    ds_read_b128 v[28:31], v6 offset:2048
    ds_read_b64_tr_b16 v[36:37], v8 offset:32
    ds_read_b64_tr_b16 v[38:39], v8 offset:4640
    ds_read_b64_tr_b16 v[40:41], v8 offset:64
    ds_read_b64_tr_b16 v[42:43], v8 offset:4672
    ds_read_b64_tr_b16 v[44:45], v8 offset:96
    ds_read_b64_tr_b16 v[46:47], v8 offset:4704
    ds_read_b64_tr_b16 v[48:49], v9 offset:0
    ds_read_b64_tr_b16 v[50:51], v9 offset:4608
    s_waitcnt lgkmcnt(0)
k1_kernel_cloop:
    s_waitcnt vmcnt(0)
    s_barrier
    s_waitcnt lgkmcnt(11)
    v_mfma_f32_16x16x32_bf16 v[128:131], v[32:35], v[16:19], v[128:131]
    ds_read_b128 v[52:55], v5 offset:0
    s_waitcnt lgkmcnt(11)
    v_mfma_f32_16x16x32_bf16 v[132:135], v[32:35], v[20:23], v[132:135]
    s_add_u32 s27, s27, 34816
    s_cmp_eq_u32 s27, 139264
    s_cselect_b32 s27, 0, s27
    ds_read_b64_tr_b16 v[68:69], v8 offset:9216
    s_waitcnt lgkmcnt(11)
    v_mfma_f32_16x16x32_bf16 v[136:139], v[32:35], v[24:27], v[136:139]
    ds_read_b64_tr_b16 v[70:71], v8 offset:13824
    s_waitcnt lgkmcnt(11)
    v_mfma_f32_16x16x32_bf16 v[140:143], v[32:35], v[28:31], v[140:143]
    ds_read_b128 v[56:59], v5 offset:2048
    v_mfma_f32_16x16x32_bf16 v[216:219], v[32:35], v[236:239], v[216:219]
    ds_read_b128 v[60:63], v7 offset:0
    s_waitcnt lgkmcnt(11)
    v_mfma_f32_16x16x32_bf16 v[144:147], v[36:39], v[16:19], v[144:147]
    ds_read_b128 v[64:67], v7 offset:2048
    v_mfma_f32_16x16x32_bf16 v[148:151], v[36:39], v[20:23], v[148:151]
    ds_read_b64_tr_b16 v[72:73], v8 offset:9248
    v_mfma_f32_16x16x32_bf16 v[152:155], v[36:39], v[24:27], v[152:155]
    ds_read_b64_tr_b16 v[74:75], v8 offset:13856
    v_mfma_f32_16x16x32_bf16 v[156:159], v[36:39], v[28:31], v[156:159]
    ds_read_b64_tr_b16 v[76:77], v8 offset:9280
    v_mfma_f32_16x16x32_bf16 v[220:223], v[36:39], v[236:239], v[220:223]
    ds_read_b64_tr_b16 v[78:79], v8 offset:13888
    s_waitcnt lgkmcnt(14)
    v_mfma_f32_16x16x32_bf16 v[160:163], v[40:43], v[16:19], v[160:163]
    ds_read_b64_tr_b16 v[80:81], v8 offset:9312
    v_mfma_f32_16x16x32_bf16 v[164:167], v[40:43], v[20:23], v[164:167]
    ds_read_b64_tr_b16 v[82:83], v8 offset:13920
    v_mfma_f32_16x16x32_bf16 v[168:171], v[40:43], v[24:27], v[168:171]
    ds_read_b64_tr_b16 v[84:85], v9 offset:9216
    v_mfma_f32_16x16x32_bf16 v[172:175], v[40:43], v[28:31], v[172:175]
    ds_read_b64_tr_b16 v[86:87], v9 offset:13824
    v_mfma_f32_16x16x32_bf16 v[224:227], v[40:43], v[236:239], v[224:227]
    v_add_u32 v4, s27, v88
    s_waitcnt lgkmcnt(15)
    v_mfma_f32_16x16x32_bf16 v[176:179], v[44:47], v[16:19], v[176:179]
    v_add_u32 v8, s27, v92
    v_mfma_f32_16x16x32_bf16 v[180:183], v[44:47], v[20:23], v[180:183]
    v_add_u32 v6, s27, v90
    v_mfma_f32_16x16x32_bf16 v[184:187], v[44:47], v[24:27], v[184:187]
    v_add_u32 v9, s27, v93
    v_mfma_f32_16x16x32_bf16 v[188:191], v[44:47], v[28:31], v[188:191]
    v_mfma_f32_16x16x32_bf16 v[228:231], v[44:47], v[236:239], v[228:231]
    s_waitcnt lgkmcnt(14)
    v_mfma_f32_16x16x32_bf16 v[192:195], v[48:51], v[16:19], v[192:195]
    v_mfma_f32_16x16x32_bf16 v[196:199], v[48:51], v[20:23], v[196:199]
    v_mfma_f32_16x16x32_bf16 v[232:235], v[48:51], v[236:239], v[232:235]
    s_waitcnt lgkmcnt(11)
    v_mfma_f32_16x16x32_bf16 v[128:131], v[68:71], v[52:55], v[128:131]
    ds_read_b128 v[16:19], v4 offset:0
    s_waitcnt lgkmcnt(11)
    v_mfma_f32_16x16x32_bf16 v[132:135], v[68:71], v[56:59], v[132:135]
    ds_read_b64_tr_b16 v[32:33], v8 offset:0
    s_waitcnt lgkmcnt(11)
    v_mfma_f32_16x16x32_bf16 v[136:139], v[68:71], v[60:63], v[136:139]
    ds_read_b64_tr_b16 v[34:35], v8 offset:4608
    s_waitcnt lgkmcnt(11)
    v_mfma_f32_16x16x32_bf16 v[140:143], v[68:71], v[64:67], v[140:143]
    ds_read_b128 v[20:23], v4 offset:2048
    v_mfma_f32_16x16x32_bf16 v[216:219], v[68:71], v[236:239], v[216:219]
    ds_read_b128 v[24:27], v6 offset:0
    s_waitcnt lgkmcnt(11)
    v_mfma_f32_16x16x32_bf16 v[144:147], v[72:75], v[52:55], v[144:147]
    ds_read_b128 v[28:31], v6 offset:2048
    v_mfma_f32_16x16x32_bf16 v[148:151], v[72:75], v[56:59], v[148:151]
    ds_read_b64_tr_b16 v[36:37], v8 offset:32
    v_mfma_f32_16x16x32_bf16 v[152:155], v[72:75], v[60:63], v[152:155]
    ds_read_b64_tr_b16 v[38:39], v8 offset:4640
    v_mfma_f32_16x16x32_bf16 v[156:159], v[72:75], v[64:67], v[156:159]
    ds_read_b64_tr_b16 v[40:41], v8 offset:64
    v_mfma_f32_16x16x32_bf16 v[220:223], v[72:75], v[236:239], v[220:223]
    ds_read_b64_tr_b16 v[42:43], v8 offset:4672
    s_waitcnt lgkmcnt(14)
    v_mfma_f32_16x16x32_bf16 v[160:163], v[76:79], v[52:55], v[160:163]
    ds_read_b64_tr_b16 v[44:45], v8 offset:96
    v_mfma_f32_16x16x32_bf16 v[164:167], v[76:79], v[56:59], v[164:167]
    ds_read_b64_tr_b16 v[46:47], v8 offset:4704
    v_mfma_f32_16x16x32_bf16 v[168:171], v[76:79], v[60:63], v[168:171]
    ds_read_b64_tr_b16 v[48:49], v9 offset:0
    v_mfma_f32_16x16x32_bf16 v[172:175], v[76:79], v[64:67], v[172:175]
    ds_read_b64_tr_b16 v[50:51], v9 offset:4608
    v_mfma_f32_16x16x32_bf16 v[224:227], v[76:79], v[236:239], v[224:227]
    v_add_u32 v5, s27, v89
    s_waitcnt lgkmcnt(15)
    v_mfma_f32_16x16x32_bf16 v[176:179], v[80:83], v[52:55], v[176:179]
    v_add_u32 v7, s27, v91
    v_mfma_f32_16x16x32_bf16 v[180:183], v[80:83], v[56:59], v[180:183]
    s_add_u32 s33, s33, 1
    v_mfma_f32_16x16x32_bf16 v[184:187], v[80:83], v[60:63], v[184:187]
    v_mfma_f32_16x16x32_bf16 v[188:191], v[80:83], v[64:67], v[188:191]
    v_mfma_f32_16x16x32_bf16 v[228:231], v[80:83], v[236:239], v[228:231]
    s_waitcnt lgkmcnt(14)
    v_mfma_f32_16x16x32_bf16 v[192:195], v[84:87], v[52:55], v[192:195]
    v_mfma_f32_16x16x32_bf16 v[196:199], v[84:87], v[56:59], v[196:199]
    v_mfma_f32_16x16x32_bf16 v[232:235], v[84:87], v[236:239], v[232:235]
    s_cmp_lt_u32 s33, 9
    s_cbranch_scc1 k1_kernel_cloop
    s_waitcnt lgkmcnt(0)
    s_cmp_eq_u32 s98, 0
    s_cbranch_scc1 k1_kernel_A1
    s_barrier
    s_load_dwordx2 s[94:95], s[0:1], 80
    s_load_dwordx2 s[92:93], s[0:1], 72
    s_mov_b32 s54, 0xbdd2d3e8
    s_mov_b32 s55, 0xbdd2d3e8
    s_mov_b32 s56, 0x3f800000
    s_mov_b32 s57, 0x3f800000
    v_mov_b32 v14, 0xc0135761
    v_mov_b32 v15, 0xc0135761
    s_lshl_b32 s36, s24, 9
    s_lshl_b32 s37, s25, 8
    s_add_u32 s38, s36, s37
    s_xor_b32 s37, s37, 256
    s_add_u32 s39, s36, s37
    v_lshlrev_b32 v10, 3, v3
    v_add_u32 v11, s38, v10
    ds_read_b64 v[100:101], v11 offset:0
    ds_read_b64 v[102:103], v11 offset:128
    v_add_u32 v11, s39, v10
    ds_read_b64 v[104:105], v11 offset:0
    ds_read_b64 v[106:107], v11 offset:128
    s_waitcnt lgkmcnt(0)
    s_mov_b32 s76, s94
    s_and_b32 s77, s95, 0xffff
    s_mov_b32 s78, 0x288000
    s_mov_b32 s79, 0x00020000
    s_mov_b32 s28, s92
    s_and_b32 s29, s93, 0xffff
    s_mov_b32 s30, 0x1000
    s_mov_b32 s31, 0x00020000
    s_call_b64 s[34:35], k1_kernel_gsub0
    s_call_b64 s[34:35], k1_kernel_gsub1
    s_call_b64 s[34:35], k1_kernel_gsub2
    s_call_b64 s[34:35], k1_kernel_gsub3
    s_call_b64 s[34:35], k1_kernel_gsub4
    v_mov_b32 v200, v16
    v_mov_b32 v201, v17
    v_mov_b32 v202, v18
    v_mov_b32 v203, v19
    v_mov_b32 v204, v20
    v_mov_b32 v205, v21
    v_mov_b32 v206, v22
    v_mov_b32 v207, v23
    v_mov_b32 v208, v24
    v_mov_b32 v209, v25
    v_mov_b32 v210, v26
    v_mov_b32 v211, v27
    v_mov_b32 v212, v28
    v_mov_b32 v213, v29
    v_mov_b32 v214, v30
    v_mov_b32 v215, v31
    v_mov_b32 v216, v32
    v_mov_b32 v217, v33
    v_mov_b32 v218, v34
    v_mov_b32 v219, v35
    v_mov_b32 v220, v36
    v_mov_b32 v221, v37
    v_mov_b32 v222, v38
    v_mov_b32 v223, v39
    v_mov_b32 v224, v40
    v_mov_b32 v225, v41
    v_mov_b32 v226, v42
    v_mov_b32 v227, v43
    v_mov_b32 v228, v44
    v_mov_b32 v229, v45
    v_mov_b32 v230, v46
    v_mov_b32 v231, v47
    v_mov_b32 v232, v48
    v_mov_b32 v233, v49
    v_mov_b32 v234, v50
    v_mov_b32 v235, v51
    s_waitcnt vmcnt(0)
    v_mov_b32 v128, v88
    v_mov_b32 v129, v89
    v_mov_b32 v130, v90
    v_mov_b32 v131, v91
    v_mov_b32 v132, v92
    v_mov_b32 v133, v93
k1_kernel_kvb:
    ds_read_b32 v16, v254 offset:0
    ds_read_b32 v17, v254 offset:144
    ds_read_b32 v18, v254 offset:288
    ds_read_b32 v19, v254 offset:432
    ds_read_b32 v20, v254 offset:576
    ds_read_b32 v21, v254 offset:720
    ds_read_b32 v22, v254 offset:864
    ds_read_b32 v23, v254 offset:1008
    ds_read_b32 v24, v254 offset:1152
    ds_read_b32 v25, v254 offset:1296
    ds_read_b32 v26, v254 offset:1440
    s_waitcnt lgkmcnt(4)
    ds_read_b32 v32, v254 offset:10240
    ds_read_b32 v33, v254 offset:10384
    ds_read_b32 v34, v254 offset:10528
    ds_read_b32 v35, v254 offset:10672
    ds_read_b32 v36, v254 offset:10816
    ds_read_b32 v37, v254 offset:10960
    ds_read_b32 v38, v254 offset:11104
    ds_read_b32 v39, v254 offset:11248
    v_mov_b32 v44, v248
    v_mov_b32 v45, v249
    v_mov_b32 v46, v250
    v_mov_b32 v47, v251
    v_mov_b32 v56, v252
    v_mov_b32 v57, v253
    s_waitcnt lgkmcnt(0)
    v_lshlrev_b32 v48, 16, v44
    v_and_b32 v49, 0xffff0000, v44
    v_lshlrev_b32 v50, 16, v45
    v_and_b32 v51, 0xffff0000, v45
    v_lshlrev_b32 v52, 16, v46
    v_and_b32 v53, 0xffff0000, v46
    v_lshlrev_b32 v54, 16, v47
    v_and_b32 v55, 0xffff0000, v47
    v_lshlrev_b32 v60, 16, v16
    v_and_b32 v72, 0xffff0000, v16
    v_lshlrev_b32 v61, 16, v17
    v_and_b32 v73, 0xffff0000, v17
    v_lshlrev_b32 v62, 16, v18
    v_and_b32 v74, 0xffff0000, v18
    v_lshlrev_b32 v63, 16, v19
    v_and_b32 v75, 0xffff0000, v19
    v_lshlrev_b32 v64, 16, v20
    v_and_b32 v76, 0xffff0000, v20
    v_lshlrev_b32 v65, 16, v21
    v_and_b32 v77, 0xffff0000, v21
    v_lshlrev_b32 v66, 16, v22
    v_and_b32 v78, 0xffff0000, v22
    v_lshlrev_b32 v67, 16, v23
    v_and_b32 v79, 0xffff0000, v23
    v_lshlrev_b32 v68, 16, v24
    v_and_b32 v80, 0xffff0000, v24
    v_lshlrev_b32 v69, 16, v25
    v_and_b32 v81, 0xffff0000, v25
    v_lshlrev_b32 v70, 16, v26
    v_and_b32 v82, 0xffff0000, v26
    v_mul_f32 v84, v60, v51
    v_mul_f32 v85, v72, v55
    v_mul_f32 v90, v61, v51
    v_mul_f32 v91, v73, v55
    v_cvt_pk_bf16_f32 v88, v84, v85
    v_lshlrev_b32 v84, 16, v88
    v_and_b32 v85, 0xffff0000, v88
    v_cvt_pk_bf16_f32 v94, v90, v91
    v_lshlrev_b32 v90, 16, v94
    v_and_b32 v91, 0xffff0000, v94
    v_mul_f32 v86, v61, v50
    v_mul_f32 v87, v73, v54
    v_mul_f32 v92, v62, v50
    v_mul_f32 v93, v74, v54
    v_cvt_pk_bf16_f32 v88, v86, v87
    v_lshlrev_b32 v86, 16, v88
    v_and_b32 v87, 0xffff0000, v88
    v_cvt_pk_bf16_f32 v94, v92, v93
    v_lshlrev_b32 v92, 16, v94
    v_and_b32 v93, 0xffff0000, v94
    v_add_f32 v84, v84, v86
    v_add_f32 v85, v85, v87
    v_add_f32 v90, v90, v92
    v_add_f32 v91, v91, v93
    v_cvt_pk_bf16_f32 v88, v84, v85
    v_lshlrev_b32 v84, 16, v88
    v_and_b32 v85, 0xffff0000, v88
    v_cvt_pk_bf16_f32 v94, v90, v91
    v_lshlrev_b32 v90, 16, v94
    v_and_b32 v91, 0xffff0000, v94
    v_mul_f32 v86, v62, v49
    v_mul_f32 v87, v74, v53
    v_mul_f32 v92, v63, v49
    v_mul_f32 v93, v75, v53
    v_cvt_pk_bf16_f32 v88, v86, v87
    v_lshlrev_b32 v86, 16, v88
    v_and_b32 v87, 0xffff0000, v88
    v_cvt_pk_bf16_f32 v94, v92, v93
    v_lshlrev_b32 v92, 16, v94
    v_and_b32 v93, 0xffff0000, v94
    v_add_f32 v84, v84, v86
    v_add_f32 v85, v85, v87
    v_add_f32 v90, v90, v92
    v_add_f32 v91, v91, v93
    v_cvt_pk_bf16_f32 v88, v84, v85
    v_lshlrev_b32 v84, 16, v88
    v_and_b32 v85, 0xffff0000, v88
    v_cvt_pk_bf16_f32 v94, v90, v91
    v_lshlrev_b32 v90, 16, v94
    v_and_b32 v91, 0xffff0000, v94
    v_mul_f32 v86, v63, v48
    v_mul_f32 v87, v75, v52
    v_mul_f32 v92, v64, v48
    v_mul_f32 v93, v76, v52
    v_cvt_pk_bf16_f32 v88, v86, v87
    v_lshlrev_b32 v86, 16, v88
    v_and_b32 v87, 0xffff0000, v88
    v_cvt_pk_bf16_f32 v94, v92, v93
    v_lshlrev_b32 v92, 16, v94
    v_and_b32 v93, 0xffff0000, v94
    v_add_f32 v84, v84, v86
    v_add_f32 v85, v85, v87
    v_add_f32 v90, v90, v92
    v_add_f32 v91, v91, v93
    v_cvt_pk_bf16_f32 v88, v84, v85
    v_lshlrev_b32 v84, 16, v88
    v_and_b32 v85, 0xffff0000, v88
    v_cvt_pk_bf16_f32 v94, v90, v91
    v_lshlrev_b32 v90, 16, v94
    v_and_b32 v91, 0xffff0000, v94
    v_lshlrev_b32 v86, 16, v32
    v_and_b32 v87, 0xffff0000, v32
    v_mul_f32 v100, v84, v86
    v_mul_f32 v108, v85, v87
    v_lshlrev_b32 v92, 16, v33
    v_and_b32 v93, 0xffff0000, v33
    v_mul_f32 v101, v90, v92
    v_mul_f32 v109, v91, v93
    v_mul_f32 v84, v62, v51
    v_mul_f32 v85, v74, v55
    v_mul_f32 v90, v63, v51
    v_mul_f32 v91, v75, v55
    v_cvt_pk_bf16_f32 v88, v84, v85
    v_lshlrev_b32 v84, 16, v88
    v_and_b32 v85, 0xffff0000, v88
    v_cvt_pk_bf16_f32 v94, v90, v91
    v_lshlrev_b32 v90, 16, v94
    v_and_b32 v91, 0xffff0000, v94
    v_mul_f32 v86, v63, v50
    v_mul_f32 v87, v75, v54
    v_mul_f32 v92, v64, v50
    v_mul_f32 v93, v76, v54
    v_cvt_pk_bf16_f32 v88, v86, v87
    v_lshlrev_b32 v86, 16, v88
    v_and_b32 v87, 0xffff0000, v88
    v_cvt_pk_bf16_f32 v94, v92, v93
    v_lshlrev_b32 v92, 16, v94
    v_and_b32 v93, 0xffff0000, v94
    v_add_f32 v84, v84, v86
    v_add_f32 v85, v85, v87
    v_add_f32 v90, v90, v92
    v_add_f32 v91, v91, v93
    v_cvt_pk_bf16_f32 v88, v84, v85
    v_lshlrev_b32 v84, 16, v88
    v_and_b32 v85, 0xffff0000, v88
    v_cvt_pk_bf16_f32 v94, v90, v91
    v_lshlrev_b32 v90, 16, v94
    v_and_b32 v91, 0xffff0000, v94
    v_mul_f32 v86, v64, v49
    v_mul_f32 v87, v76, v53
    v_mul_f32 v92, v65, v49
    v_mul_f32 v93, v77, v53
    v_cvt_pk_bf16_f32 v88, v86, v87
    v_lshlrev_b32 v86, 16, v88
    v_and_b32 v87, 0xffff0000, v88
    v_cvt_pk_bf16_f32 v94, v92, v93
    v_lshlrev_b32 v92, 16, v94
    v_and_b32 v93, 0xffff0000, v94
    v_add_f32 v84, v84, v86
    v_add_f32 v85, v85, v87
    v_add_f32 v90, v90, v92
    v_add_f32 v91, v91, v93
    v_cvt_pk_bf16_f32 v88, v84, v85
    v_lshlrev_b32 v84, 16, v88
    v_and_b32 v85, 0xffff0000, v88
    v_cvt_pk_bf16_f32 v94, v90, v91
    v_lshlrev_b32 v90, 16, v94
    v_and_b32 v91, 0xffff0000, v94
    v_mul_f32 v86, v65, v48
    v_mul_f32 v87, v77, v52
    v_mul_f32 v92, v66, v48
    v_mul_f32 v93, v78, v52
    v_cvt_pk_bf16_f32 v88, v86, v87
    v_lshlrev_b32 v86, 16, v88
    v_and_b32 v87, 0xffff0000, v88
    v_cvt_pk_bf16_f32 v94, v92, v93
    v_lshlrev_b32 v92, 16, v94
    v_and_b32 v93, 0xffff0000, v94
    v_add_f32 v84, v84, v86
    v_add_f32 v85, v85, v87
    v_add_f32 v90, v90, v92
    v_add_f32 v91, v91, v93
    v_cvt_pk_bf16_f32 v88, v84, v85
    v_lshlrev_b32 v84, 16, v88
    v_and_b32 v85, 0xffff0000, v88
    v_cvt_pk_bf16_f32 v94, v90, v91
    v_lshlrev_b32 v90, 16, v94
    v_and_b32 v91, 0xffff0000, v94
    v_lshlrev_b32 v86, 16, v34
    v_and_b32 v87, 0xffff0000, v34
    v_mul_f32 v102, v84, v86
    v_mul_f32 v110, v85, v87
    v_lshlrev_b32 v92, 16, v35
    v_and_b32 v93, 0xffff0000, v35
    v_mul_f32 v103, v90, v92
    v_mul_f32 v111, v91, v93
    v_mul_f32 v84, v64, v51
    v_mul_f32 v85, v76, v55
    v_mul_f32 v90, v65, v51
    v_mul_f32 v91, v77, v55
    v_cvt_pk_bf16_f32 v88, v84, v85
    v_lshlrev_b32 v84, 16, v88
    v_and_b32 v85, 0xffff0000, v88
    v_cvt_pk_bf16_f32 v94, v90, v91
    v_lshlrev_b32 v90, 16, v94
    v_and_b32 v91, 0xffff0000, v94
    v_mul_f32 v86, v65, v50
    v_mul_f32 v87, v77, v54
    v_mul_f32 v92, v66, v50
    v_mul_f32 v93, v78, v54
    v_cvt_pk_bf16_f32 v88, v86, v87
    v_lshlrev_b32 v86, 16, v88
    v_and_b32 v87, 0xffff0000, v88
    v_cvt_pk_bf16_f32 v94, v92, v93
    v_lshlrev_b32 v92, 16, v94
    v_and_b32 v93, 0xffff0000, v94
    v_add_f32 v84, v84, v86
    v_add_f32 v85, v85, v87
    v_add_f32 v90, v90, v92
    v_add_f32 v91, v91, v93
    v_cvt_pk_bf16_f32 v88, v84, v85
    v_lshlrev_b32 v84, 16, v88
    v_and_b32 v85, 0xffff0000, v88
    v_cvt_pk_bf16_f32 v94, v90, v91
    v_lshlrev_b32 v90, 16, v94
    v_and_b32 v91, 0xffff0000, v94
    v_mul_f32 v86, v66, v49
    v_mul_f32 v87, v78, v53
    v_mul_f32 v92, v67, v49
    v_mul_f32 v93, v79, v53
    v_cvt_pk_bf16_f32 v88, v86, v87
    v_lshlrev_b32 v86, 16, v88
    v_and_b32 v87, 0xffff0000, v88
    v_cvt_pk_bf16_f32 v94, v92, v93
    v_lshlrev_b32 v92, 16, v94
    v_and_b32 v93, 0xffff0000, v94
    v_add_f32 v84, v84, v86
    v_add_f32 v85, v85, v87
    v_add_f32 v90, v90, v92
    v_add_f32 v91, v91, v93
    v_cvt_pk_bf16_f32 v88, v84, v85
    v_lshlrev_b32 v84, 16, v88
    v_and_b32 v85, 0xffff0000, v88
    v_cvt_pk_bf16_f32 v94, v90, v91
    v_lshlrev_b32 v90, 16, v94
    v_and_b32 v91, 0xffff0000, v94
    v_mul_f32 v86, v67, v48
    v_mul_f32 v87, v79, v52
    v_mul_f32 v92, v68, v48
    v_mul_f32 v93, v80, v52
    v_cvt_pk_bf16_f32 v88, v86, v87
    v_lshlrev_b32 v86, 16, v88
    v_and_b32 v87, 0xffff0000, v88
    v_cvt_pk_bf16_f32 v94, v92, v93
    v_lshlrev_b32 v92, 16, v94
    v_and_b32 v93, 0xffff0000, v94
    v_add_f32 v84, v84, v86
    v_add_f32 v85, v85, v87
    v_add_f32 v90, v90, v92
    v_add_f32 v91, v91, v93
    v_cvt_pk_bf16_f32 v88, v84, v85
    v_lshlrev_b32 v84, 16, v88
    v_and_b32 v85, 0xffff0000, v88
    v_cvt_pk_bf16_f32 v94, v90, v91
    v_lshlrev_b32 v90, 16, v94
    v_and_b32 v91, 0xffff0000, v94
    v_lshlrev_b32 v86, 16, v36
    v_and_b32 v87, 0xffff0000, v36
    v_mul_f32 v104, v84, v86
    v_mul_f32 v112, v85, v87
    v_lshlrev_b32 v92, 16, v37
    v_and_b32 v93, 0xffff0000, v37
    v_mul_f32 v105, v90, v92
    v_mul_f32 v113, v91, v93
    v_mul_f32 v84, v66, v51
    v_mul_f32 v85, v78, v55
    v_mul_f32 v90, v67, v51
    v_mul_f32 v91, v79, v55
    v_cvt_pk_bf16_f32 v88, v84, v85
    v_lshlrev_b32 v84, 16, v88
    v_and_b32 v85, 0xffff0000, v88
    v_cvt_pk_bf16_f32 v94, v90, v91
    v_lshlrev_b32 v90, 16, v94
    v_and_b32 v91, 0xffff0000, v94
    v_mul_f32 v86, v67, v50
    v_mul_f32 v87, v79, v54
    v_mul_f32 v92, v68, v50
    v_mul_f32 v93, v80, v54
    v_cvt_pk_bf16_f32 v88, v86, v87
    v_lshlrev_b32 v86, 16, v88
    v_and_b32 v87, 0xffff0000, v88
    v_cvt_pk_bf16_f32 v94, v92, v93
    v_lshlrev_b32 v92, 16, v94
    v_and_b32 v93, 0xffff0000, v94
    v_add_f32 v84, v84, v86
    v_add_f32 v85, v85, v87
    v_add_f32 v90, v90, v92
    v_add_f32 v91, v91, v93
    v_cvt_pk_bf16_f32 v88, v84, v85
    v_lshlrev_b32 v84, 16, v88
    v_and_b32 v85, 0xffff0000, v88
    v_cvt_pk_bf16_f32 v94, v90, v91
    v_lshlrev_b32 v90, 16, v94
    v_and_b32 v91, 0xffff0000, v94
    v_mul_f32 v86, v68, v49
    v_mul_f32 v87, v80, v53
    v_mul_f32 v92, v69, v49
    v_mul_f32 v93, v81, v53
    v_cvt_pk_bf16_f32 v88, v86, v87
    v_lshlrev_b32 v86, 16, v88
    v_and_b32 v87, 0xffff0000, v88
    v_cvt_pk_bf16_f32 v94, v92, v93
    v_lshlrev_b32 v92, 16, v94
    v_and_b32 v93, 0xffff0000, v94
    v_add_f32 v84, v84, v86
    v_add_f32 v85, v85, v87
    v_add_f32 v90, v90, v92
    v_add_f32 v91, v91, v93
    v_cvt_pk_bf16_f32 v88, v84, v85
    v_lshlrev_b32 v84, 16, v88
    v_and_b32 v85, 0xffff0000, v88
    v_cvt_pk_bf16_f32 v94, v90, v91
    v_lshlrev_b32 v90, 16, v94
    v_and_b32 v91, 0xffff0000, v94
    v_mul_f32 v86, v69, v48
    v_mul_f32 v87, v81, v52
    v_mul_f32 v92, v70, v48
    v_mul_f32 v93, v82, v52
    v_cvt_pk_bf16_f32 v88, v86, v87
    v_lshlrev_b32 v86, 16, v88
    v_and_b32 v87, 0xffff0000, v88
    v_cvt_pk_bf16_f32 v94, v92, v93
    v_lshlrev_b32 v92, 16, v94
    v_and_b32 v93, 0xffff0000, v94
    v_add_f32 v84, v84, v86
    v_add_f32 v85, v85, v87
    v_add_f32 v90, v90, v92
    v_add_f32 v91, v91, v93
    v_cvt_pk_bf16_f32 v88, v84, v85
    v_lshlrev_b32 v84, 16, v88
    v_and_b32 v85, 0xffff0000, v88
    v_cvt_pk_bf16_f32 v94, v90, v91
    v_lshlrev_b32 v90, 16, v94
    v_and_b32 v91, 0xffff0000, v94
    v_lshlrev_b32 v86, 16, v38
    v_and_b32 v87, 0xffff0000, v38
    v_mul_f32 v106, v84, v86
    v_mul_f32 v114, v85, v87
    v_lshlrev_b32 v92, 16, v39
    v_and_b32 v93, 0xffff0000, v39
    v_mul_f32 v107, v90, v92
    v_mul_f32 v115, v91, v93
    v_cvt_pk_bf16_f32 v120, v107, v106
    v_cvt_pk_bf16_f32 v121, v105, v104
    v_cvt_pk_bf16_f32 v122, v103, v102
    v_cvt_pk_bf16_f32 v123, v101, v100
    v_cvt_pk_bf16_f32 v124, v115, v114
    v_cvt_pk_bf16_f32 v125, v113, v112
    v_cvt_pk_bf16_f32 v126, v111, v110
    v_cvt_pk_bf16_f32 v127, v109, v108
    v_lshlrev_b32 v12, 11, v57
    v_sub_u32 v13, 2040, v56
    v_lshl_add_u32 v12, v13, 1, v12
    v_add_u32 v13, 4096, v12
    s_mov_b32 s39, 0x2200000
    buffer_store_dwordx4 v[120:123], v12, s[12:15], s39 offen sc1
    buffer_store_dwordx4 v[124:127], v13, s[12:15], s39 offen sc1
    s_cmp_lg_u32 s41, 0
    s_cbranch_scc1 k1_kernel_kvbx
    s_cmp_lg_u32 s3, 0
    s_cbranch_scc1 k1_kernel_kvbx
    s_mov_b32 s41, 1
    v_mov_b32 v248, v244
    v_mov_b32 v249, v245
    v_mov_b32 v250, v246
    v_mov_b32 v251, v247
    v_add_u32 v253, 128, v253
    v_add_u32 v254, 128, v254
    s_mov_b64 exec, 0xffffffff
    s_branch k1_kernel_kvb
k1_kernel_kvbx:
    s_mov_b64 exec, -1
    v_mov_b32 v240, v128
    v_mov_b32 v241, v129
    v_mov_b32 v242, v130
    v_mov_b32 v243, v131
    v_mov_b32 v244, v132
    v_mov_b32 v245, v133
k1_kernel_kvbd:
    v_mov_b32 v88, v240
    v_mov_b32 v89, v241
    v_mov_b32 v90, v242
    v_mov_b32 v91, v243
    v_mov_b32 v92, v244
    v_mov_b32 v93, v245
    s_mov_b32 s42, s2
    s_mul_i32 s36, s42, 720
    s_mov_b32 s37, 0x1999999a
    s_mov_b32 s38, 0xe38e38f
    s_mov_b32 s40, 0x1e00000
    v_add_u32 v16, s36, v0
    v_mul_hi_u32 v17, v16, s37
    v_mul_u32_u24 v18, 10, v17
    v_sub_u32 v18, v16, v18
    v_lshrrev_b32 v19, 7, v17
    v_and_b32 v20, 127, v17
    v_mul_hi_u32 v21, v19, s38
    v_mul_u32_u24 v22, 18, v21
    v_sub_u32 v22, v19, v22
    v_and_b32 v23, 0x63, v20
    v_bfe_u32 v24, v20, 2, 2
    v_lshl_add_u32 v23, v24, 3, v23
    v_bfe_u32 v24, v20, 4, 1
    v_lshl_add_u32 v23, v24, 2, v23
    v_lshl_add_u32 v23, v22, 7, v23
    v_mul_u32_u24 v23, 1152, v23
    v_lshrrev_b32 v24, 1, v21
    v_mul_u32_u24 v24, 288, v24
    v_add_u32 v23, v23, v24
    v_lshl_add_u32 v23, v18, 4, v23
    v_and_b32 v24, 1, v21
    v_cmp_gt_u32 vcc, 8, v18
    v_mul_u32_u24 v24, 160, v24
    v_lshlrev_b32 v112, 4, v16
    v_cndmask_b32 v24, 0, v24, vcc
    v_add_u32 v23, v23, v24
    buffer_load_dwordx4 v[100:103], v23, s[76:79], 0 offen
    v_add_u32 v16, s36, v0
    v_add_u32 v16, 256, v16
    v_mul_hi_u32 v17, v16, s37
    v_mul_u32_u24 v18, 10, v17
    v_sub_u32 v18, v16, v18
    v_lshrrev_b32 v19, 7, v17
    v_and_b32 v20, 127, v17
    v_mul_hi_u32 v21, v19, s38
    v_mul_u32_u24 v22, 18, v21
    v_sub_u32 v22, v19, v22
    v_and_b32 v23, 0x63, v20
    v_bfe_u32 v24, v20, 2, 2
    v_lshl_add_u32 v23, v24, 3, v23
    v_bfe_u32 v24, v20, 4, 1
    v_lshl_add_u32 v23, v24, 2, v23
    v_lshl_add_u32 v23, v22, 7, v23
    v_mul_u32_u24 v23, 1152, v23
    v_lshrrev_b32 v24, 1, v21
    v_mul_u32_u24 v24, 288, v24
    v_add_u32 v23, v23, v24
    v_lshl_add_u32 v23, v18, 4, v23
    v_and_b32 v24, 1, v21
    v_cmp_gt_u32 vcc, 8, v18
    v_mul_u32_u24 v24, 160, v24
    v_lshlrev_b32 v113, 4, v16
    v_cndmask_b32 v24, 0, v24, vcc
    v_add_u32 v23, v23, v24
    buffer_load_dwordx4 v[104:107], v23, s[76:79], 0 offen
    v_add_u32 v16, s36, v0
    v_add_u32 v16, 512, v16
    v_mul_hi_u32 v17, v16, s37
    v_mul_u32_u24 v18, 10, v17
    v_sub_u32 v18, v16, v18
    v_lshrrev_b32 v19, 7, v17
    v_and_b32 v20, 127, v17
    v_mul_hi_u32 v21, v19, s38
    v_mul_u32_u24 v22, 18, v21
    v_sub_u32 v22, v19, v22
    v_and_b32 v23, 0x63, v20
    v_bfe_u32 v24, v20, 2, 2
    v_lshl_add_u32 v23, v24, 3, v23
    v_bfe_u32 v24, v20, 4, 1
    v_lshl_add_u32 v23, v24, 2, v23
    v_lshl_add_u32 v23, v22, 7, v23
    v_mul_u32_u24 v23, 1152, v23
    v_lshrrev_b32 v24, 1, v21
    v_mul_u32_u24 v24, 288, v24
    v_add_u32 v23, v23, v24
    v_lshl_add_u32 v23, v18, 4, v23
    v_and_b32 v24, 1, v21
    v_cmp_gt_u32 vcc, 8, v18
    v_mul_u32_u24 v24, 160, v24
    v_lshlrev_b32 v114, 4, v16
    v_cndmask_b32 v24, 0, v24, vcc
    v_add_u32 v23, v23, v24
    v_cmp_gt_u32 vcc, 208, v0
    v_mov_b32 v24, 0x7ffffff0
    s_nop 0
    v_cndmask_b32 v23, v24, v23, vcc
    v_cndmask_b32 v114, v24, v114, vcc
    buffer_load_dwordx4 v[108:111], v23, s[76:79], 0 offen
    s_lshl_b32 s36, s22, 7
    s_lshl_b32 s37, s24, 6
    s_add_u32 s36, s36, s37
    v_lshlrev_b32 v11, 1, v3
    s_lshl_b32 s37, s25, 6
    s_lshl_b32 s38, s36, 1
    s_add_u32 s39, s38, s37
    s_xor_b32 s37, s37, 64
    s_add_u32 s36, s38, s37
    buffer_load_ushort v96, v11, s[28:31], s39 offen
    buffer_load_ushort v97, v11, s[28:31], s39 offen offset:32
    buffer_load_ushort v98, v11, s[28:31], s36 offen
    buffer_load_ushort v99, v11, s[28:31], s36 offen offset:32
    v_mov_b32 v128, 0
    v_mov_b32 v129, 0
    v_mov_b32 v130, 0
    v_mov_b32 v131, 0
    v_mov_b32 v132, 0
    v_mov_b32 v133, 0
    v_mov_b32 v134, 0
    v_mov_b32 v135, 0
    v_mov_b32 v136, 0
    v_mov_b32 v137, 0
    v_mov_b32 v138, 0
    v_mov_b32 v139, 0
    v_mov_b32 v140, 0
    v_mov_b32 v141, 0
    v_mov_b32 v142, 0
    v_mov_b32 v143, 0
    v_mov_b32 v144, 0
    v_mov_b32 v145, 0
    v_mov_b32 v146, 0
    v_mov_b32 v147, 0
    v_mov_b32 v148, 0
    v_mov_b32 v149, 0
    v_mov_b32 v150, 0
    v_mov_b32 v151, 0
    v_mov_b32 v152, 0
    v_mov_b32 v153, 0
    v_mov_b32 v154, 0
    v_mov_b32 v155, 0
    v_mov_b32 v156, 0
    v_mov_b32 v157, 0
    v_mov_b32 v158, 0
    v_mov_b32 v159, 0
    v_mov_b32 v160, 0
    v_mov_b32 v161, 0
    v_mov_b32 v162, 0
    v_mov_b32 v163, 0
    v_mov_b32 v164, 0
    v_mov_b32 v165, 0
    v_mov_b32 v166, 0
    v_mov_b32 v167, 0
    v_mov_b32 v168, 0
    v_mov_b32 v169, 0
    v_mov_b32 v170, 0
    v_mov_b32 v171, 0
    v_mov_b32 v172, 0
    v_mov_b32 v173, 0
    v_mov_b32 v174, 0
    v_mov_b32 v175, 0
    v_mov_b32 v176, 0
    v_mov_b32 v177, 0
    v_mov_b32 v178, 0
    v_mov_b32 v179, 0
    v_mov_b32 v180, 0
    v_mov_b32 v181, 0
    v_mov_b32 v182, 0
    v_mov_b32 v183, 0
    v_mov_b32 v184, 0
    v_mov_b32 v185, 0
    v_mov_b32 v186, 0
    v_mov_b32 v187, 0
    v_mov_b32 v188, 0
    v_mov_b32 v189, 0
    v_mov_b32 v190, 0
    v_mov_b32 v191, 0
    v_mov_b32 v192, 0
    v_mov_b32 v193, 0
    v_mov_b32 v194, 0
    v_mov_b32 v195, 0
    v_mov_b32 v196, 0
    v_mov_b32 v197, 0
    v_mov_b32 v198, 0
    v_mov_b32 v199, 0
    v_lshrrev_b32 v10, 2, v2
    v_lshlrev_b32 v10, 5, v10
    v_and_b32 v11, 3, v2
    v_lshl_add_u32 v10, v11, 3, v10
    v_add_u32 v10, 20480, v10
    s_mul_i32 s26, s25, 10240
    v_add_u32 v92, s26, v10
    v_add_u32 v93, 8192, v10
    s_mov_b32 s27, 0
    v_add_u32 v4, s27, v88
    v_add_u32 v6, s27, v90
    v_add_u32 v5, s27, v89
    v_add_u32 v7, s27, v91
    v_add_u32 v8, s27, v92
    v_add_u32 v9, s27, v93
    s_mov_b32 s33, 0
    s_barrier
    ds_read_b128 v[16:19], v4 offset:0
    ds_read_b64_tr_b16 v[32:33], v8 offset:0
    ds_read_b64_tr_b16 v[34:35], v8 offset:512
    ds_read_b128 v[20:23], v4 offset:2048
    ds_read_b128 v[24:27], v6 offset:0
    ds_read_b128 v[28:31], v6 offset:2048
    ds_read_b64_tr_b16 v[36:37], v8 offset:2048
    ds_read_b64_tr_b16 v[38:39], v8 offset:2560
    ds_read_b64_tr_b16 v[40:41], v8 offset:4096
    ds_read_b64_tr_b16 v[42:43], v8 offset:4608
    ds_read_b64_tr_b16 v[44:45], v8 offset:6144
    ds_read_b64_tr_b16 v[46:47], v8 offset:6656
    ds_read_b64_tr_b16 v[48:49], v9 offset:0
    ds_read_b64_tr_b16 v[50:51], v9 offset:512
    s_waitcnt lgkmcnt(0)
k1_kernel_gloop:
    s_barrier
    s_waitcnt lgkmcnt(11)
    v_mfma_f32_16x16x32_bf16 v[128:131], v[32:35], v[16:19], v[128:131]
    ds_read_b128 v[52:55], v5 offset:0
    s_waitcnt lgkmcnt(11)
    v_mfma_f32_16x16x32_bf16 v[132:135], v[32:35], v[20:23], v[132:135]
    s_add_u32 s27, s27, 34816
    s_cmp_eq_u32 s27, 139264
    s_cselect_b32 s27, 0, s27
    ds_read_b64_tr_b16 v[68:69], v8 offset:1024
    s_waitcnt lgkmcnt(11)
    v_mfma_f32_16x16x32_bf16 v[136:139], v[32:35], v[24:27], v[136:139]
    ds_read_b64_tr_b16 v[70:71], v8 offset:1536
    s_waitcnt lgkmcnt(11)
    v_mfma_f32_16x16x32_bf16 v[140:143], v[32:35], v[28:31], v[140:143]
    ds_read_b128 v[56:59], v5 offset:2048
    s_waitcnt lgkmcnt(10)
    v_mfma_f32_16x16x32_bf16 v[144:147], v[36:39], v[16:19], v[144:147]
    ds_read_b128 v[60:63], v7 offset:0
    v_mfma_f32_16x16x32_bf16 v[148:151], v[36:39], v[20:23], v[148:151]
    ds_read_b128 v[64:67], v7 offset:2048
    v_mfma_f32_16x16x32_bf16 v[152:155], v[36:39], v[24:27], v[152:155]
    ds_read_b64_tr_b16 v[72:73], v8 offset:3072
    v_mfma_f32_16x16x32_bf16 v[156:159], v[36:39], v[28:31], v[156:159]
    ds_read_b64_tr_b16 v[74:75], v8 offset:3584
    s_waitcnt lgkmcnt(12)
    v_mfma_f32_16x16x32_bf16 v[160:163], v[40:43], v[16:19], v[160:163]
    ds_read_b64_tr_b16 v[76:77], v8 offset:5120
    v_mfma_f32_16x16x32_bf16 v[164:167], v[40:43], v[20:23], v[164:167]
    ds_read_b64_tr_b16 v[78:79], v8 offset:5632
    v_mfma_f32_16x16x32_bf16 v[168:171], v[40:43], v[24:27], v[168:171]
    ds_read_b64_tr_b16 v[80:81], v8 offset:7168
    v_mfma_f32_16x16x32_bf16 v[172:175], v[40:43], v[28:31], v[172:175]
    ds_read_b64_tr_b16 v[82:83], v8 offset:7680
    s_waitcnt lgkmcnt(14)
    v_mfma_f32_16x16x32_bf16 v[176:179], v[44:47], v[16:19], v[176:179]
    ds_read_b64_tr_b16 v[84:85], v9 offset:1024
    v_mfma_f32_16x16x32_bf16 v[180:183], v[44:47], v[20:23], v[180:183]
    ds_read_b64_tr_b16 v[86:87], v9 offset:1536
    v_mfma_f32_16x16x32_bf16 v[184:187], v[44:47], v[24:27], v[184:187]
    v_add_u32 v4, s27, v88
    v_mfma_f32_16x16x32_bf16 v[188:191], v[44:47], v[28:31], v[188:191]
    v_add_u32 v8, s27, v92
    s_waitcnt lgkmcnt(14)
    v_mfma_f32_16x16x32_bf16 v[192:195], v[48:51], v[16:19], v[192:195]
    v_add_u32 v6, s27, v90
    v_mfma_f32_16x16x32_bf16 v[196:199], v[48:51], v[20:23], v[196:199]
    v_add_u32 v9, s27, v93
    s_waitcnt lgkmcnt(11)
    v_mfma_f32_16x16x32_bf16 v[128:131], v[68:71], v[52:55], v[128:131]
    ds_read_b128 v[16:19], v4 offset:0
    s_waitcnt lgkmcnt(11)
    v_mfma_f32_16x16x32_bf16 v[132:135], v[68:71], v[56:59], v[132:135]
    ds_read_b64_tr_b16 v[32:33], v8 offset:0
    s_waitcnt lgkmcnt(11)
    v_mfma_f32_16x16x32_bf16 v[136:139], v[68:71], v[60:63], v[136:139]
    ds_read_b64_tr_b16 v[34:35], v8 offset:512
    s_waitcnt lgkmcnt(11)
    v_mfma_f32_16x16x32_bf16 v[140:143], v[68:71], v[64:67], v[140:143]
    ds_read_b128 v[20:23], v4 offset:2048
    s_waitcnt lgkmcnt(10)
    v_mfma_f32_16x16x32_bf16 v[144:147], v[72:75], v[52:55], v[144:147]
    ds_read_b128 v[24:27], v6 offset:0
    v_mfma_f32_16x16x32_bf16 v[148:151], v[72:75], v[56:59], v[148:151]
    ds_read_b128 v[28:31], v6 offset:2048
    v_mfma_f32_16x16x32_bf16 v[152:155], v[72:75], v[60:63], v[152:155]
    ds_read_b64_tr_b16 v[36:37], v8 offset:2048
    v_mfma_f32_16x16x32_bf16 v[156:159], v[72:75], v[64:67], v[156:159]
    ds_read_b64_tr_b16 v[38:39], v8 offset:2560
    s_waitcnt lgkmcnt(12)
    v_mfma_f32_16x16x32_bf16 v[160:163], v[76:79], v[52:55], v[160:163]
    ds_read_b64_tr_b16 v[40:41], v8 offset:4096
    v_mfma_f32_16x16x32_bf16 v[164:167], v[76:79], v[56:59], v[164:167]
    ds_read_b64_tr_b16 v[42:43], v8 offset:4608
    v_mfma_f32_16x16x32_bf16 v[168:171], v[76:79], v[60:63], v[168:171]
    ds_read_b64_tr_b16 v[44:45], v8 offset:6144
    v_mfma_f32_16x16x32_bf16 v[172:175], v[76:79], v[64:67], v[172:175]
    ds_read_b64_tr_b16 v[46:47], v8 offset:6656
    s_waitcnt lgkmcnt(14)
    v_mfma_f32_16x16x32_bf16 v[176:179], v[80:83], v[52:55], v[176:179]
    ds_read_b64_tr_b16 v[48:49], v9 offset:0
    v_mfma_f32_16x16x32_bf16 v[180:183], v[80:83], v[56:59], v[180:183]
    ds_read_b64_tr_b16 v[50:51], v9 offset:512
    v_mfma_f32_16x16x32_bf16 v[184:187], v[80:83], v[60:63], v[184:187]
    v_add_u32 v5, s27, v89
    v_mfma_f32_16x16x32_bf16 v[188:191], v[80:83], v[64:67], v[188:191]
    v_add_u32 v7, s27, v91
    s_waitcnt lgkmcnt(14)
    v_mfma_f32_16x16x32_bf16 v[192:195], v[84:87], v[52:55], v[192:195]
    s_add_u32 s33, s33, 1
    v_mfma_f32_16x16x32_bf16 v[196:199], v[84:87], v[56:59], v[196:199]
    s_cmp_lg_u32 s33, 3
    s_cbranch_scc1 k1_kernel_ghk0
    s_waitcnt vmcnt(0)
    buffer_store_dwordx4 v[100:103], v112, s[12:15], s40 offen sc1
    buffer_store_dwordx4 v[104:107], v113, s[12:15], s40 offen sc1
    buffer_store_dwordx4 v[108:111], v114, s[12:15], s40 offen sc1
    v_lshlrev_b32 v236, 16, v96
    v_lshlrev_b32 v238, 16, v97
    v_lshlrev_b32 v240, 16, v98
    v_lshlrev_b32 v242, 16, v99
k1_kernel_ghk0:
    s_cmp_lg_u32 s33, 6
    s_cbranch_scc1 k1_kernel_ghk
    s_waitcnt vmcnt(0)
    v_mov_b32 v10, 2056
    v_mov_b32 v11, 1
    s_mov_b64 exec, 1
    ds_add_rtn_u32 v12, v10, v11
    s_waitcnt lgkmcnt(0)
    v_readfirstlane_b32 s36, v12
    s_cmp_lg_u32 s36, 3
    s_cbranch_scc1 k1_kernel_nokvs
    s_lshl_b32 s36, s2, 7
    s_add_u32 s36, s36, 0x2d20000
    v_mov_b32 v10, 0
    buffer_store_dword v11, v10, s[12:15], s36 offen sc1
k1_kernel_nokvs:
    s_mov_b64 exec, -1
k1_kernel_ghk:
    s_cmp_lt_u32 s33, 32
    s_cbranch_scc1 k1_kernel_gloop
    s_waitcnt lgkmcnt(0)
    v_lshrrev_b32 v10, 4, v2
    v_and_b32 v11, 1, v10
    v_lshrrev_b32 v12, 1, v10
    v_lshlrev_b32 v4, 5, v3
    v_lshl_add_u32 v4, v11, 9, v4
    v_lshl_add_u32 v4, v12, 4, v4
    s_lshl_b32 s37, s22, 1
    s_add_u32 s37, s37, s24
    s_mul_i32 s37, s37, 144
    s_mul_i32 s36, s23, 9
    s_add_u32 s37, s37, s36
    s_lshl_b32 s37, s37, 11
    s_add_u32 s37, s37, 0x1400000
    s_lshl_b32 s38, s25, 10
    s_add_u32 s35, s37, s38
    s_add_u32 s35, s35, 8192
    s_mul_i32 s36, s25, 10240
    s_add_u32 s37, s37, s36
    s_add_u32 s39, s37, s38
    s_xor_b32 s38, s38, 1024
    s_add_u32 s40, s37, s38
    s_add_u32 s36, s39, 4096
    s_add_u32 s37, s40, 4096
    v_pk_add_f32 v[128:129], v[128:129], v[236:237] op_sel_hi:[1,0]
    v_pk_add_f32 v[130:131], v[130:131], v[236:237] op_sel_hi:[1,0]
    v_pk_add_f32 v[132:133], v[132:133], v[238:239] op_sel_hi:[1,0]
    v_pk_add_f32 v[134:135], v[134:135], v[238:239] op_sel_hi:[1,0]
    v_cvt_pk_bf16_f32 v24, v128, v129
    v_cvt_pk_bf16_f32 v25, v130, v131
    v_cvt_pk_bf16_f32 v26, v132, v133
    v_cvt_pk_bf16_f32 v27, v134, v135
    v_lshlrev_b32 v128, 16, v24
    v_and_b32 v129, 0xffff0000, v24
    v_lshlrev_b32 v28, 16, v200
    v_and_b32 v29, 0xffff0000, v200
    v_lshlrev_b32 v130, 16, v25
    v_and_b32 v131, 0xffff0000, v25
    v_lshlrev_b32 v30, 16, v201
    v_and_b32 v31, 0xffff0000, v201
    v_lshlrev_b32 v132, 16, v26
    v_and_b32 v133, 0xffff0000, v26
    v_lshlrev_b32 v32, 16, v202
    v_and_b32 v33, 0xffff0000, v202
    v_lshlrev_b32 v134, 16, v27
    v_and_b32 v135, 0xffff0000, v27
    v_lshlrev_b32 v34, 16, v203
    v_and_b32 v35, 0xffff0000, v203
    v_pk_mul_f32 v[128:129], v[128:129], v[28:29]
    v_pk_mul_f32 v[130:131], v[130:131], v[30:31]
    v_pk_mul_f32 v[132:133], v[132:133], v[32:33]
    v_pk_mul_f32 v[134:135], v[134:135], v[34:35]
    v_cvt_pk_bf16_f32 v40, v128, v129
    v_cvt_pk_bf16_f32 v41, v130, v131
    v_cvt_pk_bf16_f32 v42, v132, v133
    v_cvt_pk_bf16_f32 v43, v134, v135
    s_nop 1
    v_permlane16_swap_b32 v40, v42
    v_permlane16_swap_b32 v41, v43
    s_nop 0
    buffer_store_dwordx4 v[40:43], v4, s[12:15], s39 offen offset:0 sc1
    v_pk_add_f32 v[136:137], v[136:137], v[240:241] op_sel_hi:[1,0]
    v_pk_add_f32 v[138:139], v[138:139], v[240:241] op_sel_hi:[1,0]
    v_pk_add_f32 v[140:141], v[140:141], v[242:243] op_sel_hi:[1,0]
    v_pk_add_f32 v[142:143], v[142:143], v[242:243] op_sel_hi:[1,0]
    v_cvt_pk_bf16_f32 v24, v136, v137
    v_cvt_pk_bf16_f32 v25, v138, v139
    v_cvt_pk_bf16_f32 v26, v140, v141
    v_cvt_pk_bf16_f32 v27, v142, v143
    v_lshlrev_b32 v136, 16, v24
    v_and_b32 v137, 0xffff0000, v24
    v_lshlrev_b32 v28, 16, v204
    v_and_b32 v29, 0xffff0000, v204
    v_lshlrev_b32 v138, 16, v25
    v_and_b32 v139, 0xffff0000, v25
    v_lshlrev_b32 v30, 16, v205
    v_and_b32 v31, 0xffff0000, v205
    v_lshlrev_b32 v140, 16, v26
    v_and_b32 v141, 0xffff0000, v26
    v_lshlrev_b32 v32, 16, v206
    v_and_b32 v33, 0xffff0000, v206
    v_lshlrev_b32 v142, 16, v27
    v_and_b32 v143, 0xffff0000, v27
    v_lshlrev_b32 v34, 16, v207
    v_and_b32 v35, 0xffff0000, v207
    v_pk_mul_f32 v[136:137], v[136:137], v[28:29]
    v_pk_mul_f32 v[138:139], v[138:139], v[30:31]
    v_pk_mul_f32 v[140:141], v[140:141], v[32:33]
    v_pk_mul_f32 v[142:143], v[142:143], v[34:35]
    v_cvt_pk_bf16_f32 v44, v136, v137
    v_cvt_pk_bf16_f32 v45, v138, v139
    v_cvt_pk_bf16_f32 v46, v140, v141
    v_cvt_pk_bf16_f32 v47, v142, v143
    s_nop 1
    v_permlane16_swap_b32 v44, v46
    v_permlane16_swap_b32 v45, v47
    s_nop 0
    buffer_store_dwordx4 v[44:47], v4, s[12:15], s40 offen offset:0 sc1
    v_pk_add_f32 v[144:145], v[144:145], v[236:237] op_sel_hi:[1,0]
    v_pk_add_f32 v[146:147], v[146:147], v[236:237] op_sel_hi:[1,0]
    v_pk_add_f32 v[148:149], v[148:149], v[238:239] op_sel_hi:[1,0]
    v_pk_add_f32 v[150:151], v[150:151], v[238:239] op_sel_hi:[1,0]
    v_cvt_pk_bf16_f32 v24, v144, v145
    v_cvt_pk_bf16_f32 v25, v146, v147
    v_cvt_pk_bf16_f32 v26, v148, v149
    v_cvt_pk_bf16_f32 v27, v150, v151
    v_lshlrev_b32 v144, 16, v24
    v_and_b32 v145, 0xffff0000, v24
    v_lshlrev_b32 v28, 16, v208
    v_and_b32 v29, 0xffff0000, v208
    v_lshlrev_b32 v146, 16, v25
    v_and_b32 v147, 0xffff0000, v25
    v_lshlrev_b32 v30, 16, v209
    v_and_b32 v31, 0xffff0000, v209
    v_lshlrev_b32 v148, 16, v26
    v_and_b32 v149, 0xffff0000, v26
    v_lshlrev_b32 v32, 16, v210
    v_and_b32 v33, 0xffff0000, v210
    v_lshlrev_b32 v150, 16, v27
    v_and_b32 v151, 0xffff0000, v27
    v_lshlrev_b32 v34, 16, v211
    v_and_b32 v35, 0xffff0000, v211
    v_pk_mul_f32 v[144:145], v[144:145], v[28:29]
    v_pk_mul_f32 v[146:147], v[146:147], v[30:31]
    v_pk_mul_f32 v[148:149], v[148:149], v[32:33]
    v_pk_mul_f32 v[150:151], v[150:151], v[34:35]
    v_cvt_pk_bf16_f32 v48, v144, v145
    v_cvt_pk_bf16_f32 v49, v146, v147
    v_cvt_pk_bf16_f32 v50, v148, v149
    v_cvt_pk_bf16_f32 v51, v150, v151
    s_nop 1
    v_permlane16_swap_b32 v48, v50
    v_permlane16_swap_b32 v49, v51
    s_nop 0
    buffer_store_dwordx4 v[48:51], v4, s[12:15], s39 offen offset:2048 sc1
    v_pk_add_f32 v[152:153], v[152:153], v[240:241] op_sel_hi:[1,0]
    v_pk_add_f32 v[154:155], v[154:155], v[240:241] op_sel_hi:[1,0]
    v_pk_add_f32 v[156:157], v[156:157], v[242:243] op_sel_hi:[1,0]
    v_pk_add_f32 v[158:159], v[158:159], v[242:243] op_sel_hi:[1,0]
    v_cvt_pk_bf16_f32 v24, v152, v153
    v_cvt_pk_bf16_f32 v25, v154, v155
    v_cvt_pk_bf16_f32 v26, v156, v157
    v_cvt_pk_bf16_f32 v27, v158, v159
    v_lshlrev_b32 v152, 16, v24
    v_and_b32 v153, 0xffff0000, v24
    v_lshlrev_b32 v28, 16, v212
    v_and_b32 v29, 0xffff0000, v212
    v_lshlrev_b32 v154, 16, v25
    v_and_b32 v155, 0xffff0000, v25
    v_lshlrev_b32 v30, 16, v213
    v_and_b32 v31, 0xffff0000, v213
    v_lshlrev_b32 v156, 16, v26
    v_and_b32 v157, 0xffff0000, v26
    v_lshlrev_b32 v32, 16, v214
    v_and_b32 v33, 0xffff0000, v214
    v_lshlrev_b32 v158, 16, v27
    v_and_b32 v159, 0xffff0000, v27
    v_lshlrev_b32 v34, 16, v215
    v_and_b32 v35, 0xffff0000, v215
    v_pk_mul_f32 v[152:153], v[152:153], v[28:29]
    v_pk_mul_f32 v[154:155], v[154:155], v[30:31]
    v_pk_mul_f32 v[156:157], v[156:157], v[32:33]
    v_pk_mul_f32 v[158:159], v[158:159], v[34:35]
    v_cvt_pk_bf16_f32 v52, v152, v153
    v_cvt_pk_bf16_f32 v53, v154, v155
    v_cvt_pk_bf16_f32 v54, v156, v157
    v_cvt_pk_bf16_f32 v55, v158, v159
    s_nop 1
    v_permlane16_swap_b32 v52, v54
    v_permlane16_swap_b32 v53, v55
    s_nop 0
    buffer_store_dwordx4 v[52:55], v4, s[12:15], s40 offen offset:2048 sc1
    v_pk_add_f32 v[160:161], v[160:161], v[236:237] op_sel_hi:[1,0]
    v_pk_add_f32 v[162:163], v[162:163], v[236:237] op_sel_hi:[1,0]
    v_pk_add_f32 v[164:165], v[164:165], v[238:239] op_sel_hi:[1,0]
    v_pk_add_f32 v[166:167], v[166:167], v[238:239] op_sel_hi:[1,0]
    v_cvt_pk_bf16_f32 v24, v160, v161
    v_cvt_pk_bf16_f32 v25, v162, v163
    v_cvt_pk_bf16_f32 v26, v164, v165
    v_cvt_pk_bf16_f32 v27, v166, v167
    v_lshlrev_b32 v160, 16, v24
    v_and_b32 v161, 0xffff0000, v24
    v_lshlrev_b32 v28, 16, v216
    v_and_b32 v29, 0xffff0000, v216
    v_lshlrev_b32 v162, 16, v25
    v_and_b32 v163, 0xffff0000, v25
    v_lshlrev_b32 v30, 16, v217
    v_and_b32 v31, 0xffff0000, v217
    v_lshlrev_b32 v164, 16, v26
    v_and_b32 v165, 0xffff0000, v26
    v_lshlrev_b32 v32, 16, v218
    v_and_b32 v33, 0xffff0000, v218
    v_lshlrev_b32 v166, 16, v27
    v_and_b32 v167, 0xffff0000, v27
    v_lshlrev_b32 v34, 16, v219
    v_and_b32 v35, 0xffff0000, v219
    v_pk_mul_f32 v[160:161], v[160:161], v[28:29]
    v_pk_mul_f32 v[162:163], v[162:163], v[30:31]
    v_pk_mul_f32 v[164:165], v[164:165], v[32:33]
    v_pk_mul_f32 v[166:167], v[166:167], v[34:35]
    v_cvt_pk_bf16_f32 v56, v160, v161
    v_cvt_pk_bf16_f32 v57, v162, v163
    v_cvt_pk_bf16_f32 v58, v164, v165
    v_cvt_pk_bf16_f32 v59, v166, v167
    s_nop 1
    v_permlane16_swap_b32 v56, v58
    v_permlane16_swap_b32 v57, v59
    s_nop 0
    buffer_store_dwordx4 v[56:59], v4, s[12:15], s36 offen offset:0 sc1
    v_pk_add_f32 v[168:169], v[168:169], v[240:241] op_sel_hi:[1,0]
    v_pk_add_f32 v[170:171], v[170:171], v[240:241] op_sel_hi:[1,0]
    v_pk_add_f32 v[172:173], v[172:173], v[242:243] op_sel_hi:[1,0]
    v_pk_add_f32 v[174:175], v[174:175], v[242:243] op_sel_hi:[1,0]
    v_cvt_pk_bf16_f32 v24, v168, v169
    v_cvt_pk_bf16_f32 v25, v170, v171
    v_cvt_pk_bf16_f32 v26, v172, v173
    v_cvt_pk_bf16_f32 v27, v174, v175
    v_lshlrev_b32 v168, 16, v24
    v_and_b32 v169, 0xffff0000, v24
    v_lshlrev_b32 v28, 16, v220
    v_and_b32 v29, 0xffff0000, v220
    v_lshlrev_b32 v170, 16, v25
    v_and_b32 v171, 0xffff0000, v25
    v_lshlrev_b32 v30, 16, v221
    v_and_b32 v31, 0xffff0000, v221
    v_lshlrev_b32 v172, 16, v26
    v_and_b32 v173, 0xffff0000, v26
    v_lshlrev_b32 v32, 16, v222
    v_and_b32 v33, 0xffff0000, v222
    v_lshlrev_b32 v174, 16, v27
    v_and_b32 v175, 0xffff0000, v27
    v_lshlrev_b32 v34, 16, v223
    v_and_b32 v35, 0xffff0000, v223
    v_pk_mul_f32 v[168:169], v[168:169], v[28:29]
    v_pk_mul_f32 v[170:171], v[170:171], v[30:31]
    v_pk_mul_f32 v[172:173], v[172:173], v[32:33]
    v_pk_mul_f32 v[174:175], v[174:175], v[34:35]
    v_cvt_pk_bf16_f32 v60, v168, v169
    v_cvt_pk_bf16_f32 v61, v170, v171
    v_cvt_pk_bf16_f32 v62, v172, v173
    v_cvt_pk_bf16_f32 v63, v174, v175
    s_nop 1
    v_permlane16_swap_b32 v60, v62
    v_permlane16_swap_b32 v61, v63
    s_nop 0
    buffer_store_dwordx4 v[60:63], v4, s[12:15], s37 offen offset:0 sc1
    v_pk_add_f32 v[176:177], v[176:177], v[236:237] op_sel_hi:[1,0]
    v_pk_add_f32 v[178:179], v[178:179], v[236:237] op_sel_hi:[1,0]
    v_pk_add_f32 v[180:181], v[180:181], v[238:239] op_sel_hi:[1,0]
    v_pk_add_f32 v[182:183], v[182:183], v[238:239] op_sel_hi:[1,0]
    v_cvt_pk_bf16_f32 v24, v176, v177
    v_cvt_pk_bf16_f32 v25, v178, v179
    v_cvt_pk_bf16_f32 v26, v180, v181
    v_cvt_pk_bf16_f32 v27, v182, v183
    v_lshlrev_b32 v176, 16, v24
    v_and_b32 v177, 0xffff0000, v24
    v_lshlrev_b32 v28, 16, v224
    v_and_b32 v29, 0xffff0000, v224
    v_lshlrev_b32 v178, 16, v25
    v_and_b32 v179, 0xffff0000, v25
    v_lshlrev_b32 v30, 16, v225
    v_and_b32 v31, 0xffff0000, v225
    v_lshlrev_b32 v180, 16, v26
    v_and_b32 v181, 0xffff0000, v26
    v_lshlrev_b32 v32, 16, v226
    v_and_b32 v33, 0xffff0000, v226
    v_lshlrev_b32 v182, 16, v27
    v_and_b32 v183, 0xffff0000, v27
    v_lshlrev_b32 v34, 16, v227
    v_and_b32 v35, 0xffff0000, v227
    v_pk_mul_f32 v[176:177], v[176:177], v[28:29]
    v_pk_mul_f32 v[178:179], v[178:179], v[30:31]
    v_pk_mul_f32 v[180:181], v[180:181], v[32:33]
    v_pk_mul_f32 v[182:183], v[182:183], v[34:35]
    v_cvt_pk_bf16_f32 v64, v176, v177
    v_cvt_pk_bf16_f32 v65, v178, v179
    v_cvt_pk_bf16_f32 v66, v180, v181
    v_cvt_pk_bf16_f32 v67, v182, v183
    s_nop 1
    v_permlane16_swap_b32 v64, v66
    v_permlane16_swap_b32 v65, v67
    s_nop 0
    buffer_store_dwordx4 v[64:67], v4, s[12:15], s36 offen offset:2048 sc1
    v_pk_add_f32 v[184:185], v[184:185], v[240:241] op_sel_hi:[1,0]
    v_pk_add_f32 v[186:187], v[186:187], v[240:241] op_sel_hi:[1,0]
    v_pk_add_f32 v[188:189], v[188:189], v[242:243] op_sel_hi:[1,0]
    v_pk_add_f32 v[190:191], v[190:191], v[242:243] op_sel_hi:[1,0]
    v_cvt_pk_bf16_f32 v24, v184, v185
    v_cvt_pk_bf16_f32 v25, v186, v187
    v_cvt_pk_bf16_f32 v26, v188, v189
    v_cvt_pk_bf16_f32 v27, v190, v191
    v_lshlrev_b32 v184, 16, v24
    v_and_b32 v185, 0xffff0000, v24
    v_lshlrev_b32 v28, 16, v228
    v_and_b32 v29, 0xffff0000, v228
    v_lshlrev_b32 v186, 16, v25
    v_and_b32 v187, 0xffff0000, v25
    v_lshlrev_b32 v30, 16, v229
    v_and_b32 v31, 0xffff0000, v229
    v_lshlrev_b32 v188, 16, v26
    v_and_b32 v189, 0xffff0000, v26
    v_lshlrev_b32 v32, 16, v230
    v_and_b32 v33, 0xffff0000, v230
    v_lshlrev_b32 v190, 16, v27
    v_and_b32 v191, 0xffff0000, v27
    v_lshlrev_b32 v34, 16, v231
    v_and_b32 v35, 0xffff0000, v231
    v_pk_mul_f32 v[184:185], v[184:185], v[28:29]
    v_pk_mul_f32 v[186:187], v[186:187], v[30:31]
    v_pk_mul_f32 v[188:189], v[188:189], v[32:33]
    v_pk_mul_f32 v[190:191], v[190:191], v[34:35]
    v_cvt_pk_bf16_f32 v68, v184, v185
    v_cvt_pk_bf16_f32 v69, v186, v187
    v_cvt_pk_bf16_f32 v70, v188, v189
    v_cvt_pk_bf16_f32 v71, v190, v191
    s_nop 1
    v_permlane16_swap_b32 v68, v70
    v_permlane16_swap_b32 v69, v71
    s_nop 0
    buffer_store_dwordx4 v[68:71], v4, s[12:15], s37 offen offset:2048 sc1
    v_pk_add_f32 v[192:193], v[192:193], v[236:237] op_sel_hi:[1,0]
    v_pk_add_f32 v[194:195], v[194:195], v[236:237] op_sel_hi:[1,0]
    v_pk_add_f32 v[196:197], v[196:197], v[238:239] op_sel_hi:[1,0]
    v_pk_add_f32 v[198:199], v[198:199], v[238:239] op_sel_hi:[1,0]
    v_cvt_pk_bf16_f32 v24, v192, v193
    v_cvt_pk_bf16_f32 v25, v194, v195
    v_cvt_pk_bf16_f32 v26, v196, v197
    v_cvt_pk_bf16_f32 v27, v198, v199
    v_lshlrev_b32 v192, 16, v24
    v_and_b32 v193, 0xffff0000, v24
    v_lshlrev_b32 v28, 16, v232
    v_and_b32 v29, 0xffff0000, v232
    v_lshlrev_b32 v194, 16, v25
    v_and_b32 v195, 0xffff0000, v25
    v_lshlrev_b32 v30, 16, v233
    v_and_b32 v31, 0xffff0000, v233
    v_lshlrev_b32 v196, 16, v26
    v_and_b32 v197, 0xffff0000, v26
    v_lshlrev_b32 v32, 16, v234
    v_and_b32 v33, 0xffff0000, v234
    v_lshlrev_b32 v198, 16, v27
    v_and_b32 v199, 0xffff0000, v27
    v_lshlrev_b32 v34, 16, v235
    v_and_b32 v35, 0xffff0000, v235
    v_pk_mul_f32 v[192:193], v[192:193], v[28:29]
    v_pk_mul_f32 v[194:195], v[194:195], v[30:31]
    v_pk_mul_f32 v[196:197], v[196:197], v[32:33]
    v_pk_mul_f32 v[198:199], v[198:199], v[34:35]
    v_cvt_pk_bf16_f32 v72, v192, v193
    v_cvt_pk_bf16_f32 v73, v194, v195
    v_cvt_pk_bf16_f32 v74, v196, v197
    v_cvt_pk_bf16_f32 v75, v198, v199
    s_nop 1
    v_permlane16_swap_b32 v72, v74
    v_permlane16_swap_b32 v73, v75
    s_nop 0
    buffer_store_dwordx4 v[72:75], v4, s[12:15], s35 offen sc1
    s_setprio 3
    s_lshl_b32 s36, s22, 4
    s_add_u32 s36, s36, s23
    s_lshl_b32 s36, s36, 8
    s_add_u32 s97, s36, 0x2d00080
    s_load_dwordx2 s[4:5], s[0:1], 0
    s_load_dwordx2 s[16:17], s[0:1], 88
    s_and_b32 s20, s2, 7
    s_lshr_b32 s21, s2, 3
    s_and_b32 s22, s20, 3
    s_lshl_b32 s22, s22, 3
    s_and_b32 s23, s21, 7
    s_add_u32 s22, s22, s23
    s_lshr_b32 s23, s20, 2
    s_lshl_b32 s23, s23, 2
    s_lshr_b32 s24, s21, 3
    s_add_u32 s23, s23, s24
    s_lshr_b32 s52, s23, 1
    s_and_b32 s53, s23, 1
    s_lshl_b32 s54, s98, 2
    s_add_u32 s54, s54, s3
    s_waitcnt lgkmcnt(0)
    s_mov_b32 s8, s4
    s_and_b32 s9, s5, 0xffff
    s_mov_b32 s10, 0x240000
    s_mov_b32 s11, 0x00020000
    s_mov_b32 s28, s16
    s_and_b32 s29, s17, 0xffff
    s_mov_b32 s30, 0x240000
    s_mov_b32 s31, 0x00020000
    v_lshlrev_b32 v14, 4, v2
    s_mul_i32 s26, s22, 294912
    s_lshl_b32 s24, s3, 12
    s_add_u32 s26, s26, s24
    s_add_u32 s26, s26, 0x1400000
    s_mul_i32 s27, s23, 368640
    s_mul_i32 s25, s3, 5120
    s_add_u32 s27, s27, s25
    s_add_u32 s27, s27, 0x1e00000
    s_add_u32 s25, s25, 16384
    v_and_b32 v28, 15, v2
    v_lshlrev_b32 v30, 7, v2
    v_mov_b32 v26, 2048
    v_mov_b32 v27, 1
    s_waitcnt vmcnt(0)
    s_mov_b64 exec, 1
    ds_add_rtn_u32 v29, v26, v27 offset:16
    s_waitcnt lgkmcnt(0)
    v_readfirstlane_b32 s36, v29
    s_cmp_lg_u32 s36, 3
    s_cbranch_scc1 k1_kernel_nops
    v_mov_b32 v29, 0
    buffer_store_dword v27, v29, s[12:15], s97 offen sc1
k1_kernel_nops:
    s_mov_b64 exec, -1
    s_mov_b32 s34, 0
k1_kernel_cw:
    ds_read_b32 v29, v26 offset:16
    s_add_u32 s34, s34, 1
    s_waitcnt lgkmcnt(0)
    v_readfirstlane_b32 s36, v29
    s_cmp_gt_u32 s34, 400000
    s_cbranch_scc1 k1_kernel_cwx
    s_cmp_ge_u32 s36, 4
    s_cbranch_scc1 k1_kernel_cwx
    s_sleep 1
    s_branch k1_kernel_cw
k1_kernel_cwx:
    s_add_u32 s38, s27, 20480
    s_add_u32 s36, s25, 77824
    s_mov_b32 m0, s36
    s_add_u32 s37, s27, 4096
    buffer_load_dwordx4 v14, s[12:15], s27 offen offset:0 sc1 lds
    buffer_load_dwordx4 v14, s[12:15], s27 offen offset:1024 sc1 lds
    buffer_load_dwordx4 v14, s[12:15], s27 offen offset:2048 sc1 lds
    buffer_load_dwordx4 v14, s[12:15], s27 offen offset:3072 sc1 lds
    s_add_u32 s36, s36, 4096
    s_mov_b32 m0, s36
    s_nop 0
    buffer_load_dwordx4 v14, s[12:15], s37 offen sc1 lds
    s_add_u32 s36, s25, 114688
    s_mov_b32 m0, s36
    s_add_u32 s37, s38, 4096
    buffer_load_dwordx4 v14, s[12:15], s38 offen offset:0 sc1 lds
    buffer_load_dwordx4 v14, s[12:15], s38 offen offset:1024 sc1 lds
    buffer_load_dwordx4 v14, s[12:15], s38 offen offset:2048 sc1 lds
    buffer_load_dwordx4 v14, s[12:15], s38 offen offset:3072 sc1 lds
    s_add_u32 s36, s36, 4096
    s_mov_b32 m0, s36
    s_nop 0
    buffer_load_dwordx4 v14, s[12:15], s37 offen sc1 lds
    s_mov_b32 s34, 0
    s_cmp_lg_u32 s3, 0
    s_cbranch_scc1 k1_kernel_cpl
    v_lshlrev_b32 v28, 8, v28
    s_lshr_b32 s39, s22, 1
    s_lshl_b32 s39, s39, 12
    s_add_u32 s39, s39, 0x2d00080
k1_kernel_cpz:
    buffer_load_dword v29, v28, s[12:15], s39 offen sc1
    s_add_u32 s34, s34, 1
    s_waitcnt vmcnt(0)
    v_cmp_ne_u32 vcc, 1, v29
    s_cmp_gt_u32 s34, 20000
    s_cbranch_scc1 k1_kernel_cpzx
    s_cbranch_vccz k1_kernel_cpzx
    s_sleep 8
    s_branch k1_kernel_cpz
k1_kernel_cpzx:
    ds_write_b32 v26, v27 offset:24
    s_branch k1_kernel_cgo
k1_kernel_cpl:
    ds_read_b32 v29, v26 offset:24
    s_add_u32 s34, s34, 1
    s_waitcnt lgkmcnt(0)
    v_readfirstlane_b32 s36, v29
    s_cmp_gt_u32 s34, 400000
    s_cbranch_scc1 k1_kernel_cgo
    s_cmp_lg_u32 s36, 0
    s_cbranch_scc1 k1_kernel_cgo
    s_sleep 2
    s_branch k1_kernel_cpl
k1_kernel_cgo:
    s_add_u32 s38, s26, 16384
    s_add_u32 s35, s24, 77824
    s_mov_b32 m0, s35
    s_nop 0
    buffer_load_dwordx4 v14, s[12:15], s26 offen offset:0 sc1 lds
    buffer_load_dwordx4 v14, s[12:15], s26 offen offset:1024 sc1 lds
    buffer_load_dwordx4 v14, s[12:15], s26 offen offset:2048 sc1 lds
    buffer_load_dwordx4 v14, s[12:15], s26 offen offset:3072 sc1 lds
    s_add_u32 s35, s24, 114688
    s_mov_b32 m0, s35
    s_nop 0
    buffer_load_dwordx4 v14, s[12:15], s38 offen offset:0 sc1 lds
    buffer_load_dwordx4 v14, s[12:15], s38 offen offset:1024 sc1 lds
    buffer_load_dwordx4 v14, s[12:15], s38 offen offset:2048 sc1 lds
    buffer_load_dwordx4 v14, s[12:15], s38 offen offset:3072 sc1 lds
    s_add_u32 s26, s26, 32768
    s_add_u32 s27, s27, 40960
    s_mov_b32 s33, 4096
    s_waitcnt vmcnt(4)
    s_barrier
    s_add_u32 s35, s24, s33
    s_mov_b32 m0, s35
    s_nop 0
    buffer_load_dwordx4 v14, s[12:15], s26 offen offset:0 sc1 lds
    buffer_load_dwordx4 v14, s[12:15], s26 offen offset:1024 sc1 lds
    buffer_load_dwordx4 v14, s[12:15], s26 offen offset:2048 sc1 lds
    buffer_load_dwordx4 v14, s[12:15], s26 offen offset:3072 sc1 lds
    s_add_u32 s36, s25, s33
    s_mov_b32 m0, s36
    s_add_u32 s37, s27, 4096
    buffer_load_dwordx4 v14, s[12:15], s27 offen offset:0 sc1 lds
    buffer_load_dwordx4 v14, s[12:15], s27 offen offset:1024 sc1 lds
    buffer_load_dwordx4 v14, s[12:15], s27 offen offset:2048 sc1 lds
    buffer_load_dwordx4 v14, s[12:15], s27 offen offset:3072 sc1 lds
    s_add_u32 s36, s36, 4096
    s_mov_b32 m0, s36
    s_nop 0
    buffer_load_dwordx4 v14, s[12:15], s37 offen sc1 lds
    s_add_u32 s26, s26, 16384
    s_add_u32 s27, s27, 20480
    s_add_u32 s33, s33, 36864
    s_cmp_eq_u32 s33, 151552
    s_cselect_b32 s33, 4096, s33
    s_add_u32 s35, s24, s33
    s_mov_b32 m0, s35
    s_nop 0
    buffer_load_dwordx4 v14, s[12:15], s26 offen offset:0 sc1 lds
    buffer_load_dwordx4 v14, s[12:15], s26 offen offset:1024 sc1 lds
    buffer_load_dwordx4 v14, s[12:15], s26 offen offset:2048 sc1 lds
    buffer_load_dwordx4 v14, s[12:15], s26 offen offset:3072 sc1 lds
    s_add_u32 s36, s25, s33
    s_mov_b32 m0, s36
    s_add_u32 s37, s27, 4096
    buffer_load_dwordx4 v14, s[12:15], s27 offen offset:0 sc1 lds
    buffer_load_dwordx4 v14, s[12:15], s27 offen offset:1024 sc1 lds
    buffer_load_dwordx4 v14, s[12:15], s27 offen offset:2048 sc1 lds
    buffer_load_dwordx4 v14, s[12:15], s27 offen offset:3072 sc1 lds
    s_add_u32 s36, s36, 4096
    s_mov_b32 m0, s36
    s_nop 0
    buffer_load_dwordx4 v14, s[12:15], s37 offen sc1 lds
    s_add_u32 s26, s26, 16384
    s_add_u32 s27, s27, 20480
    s_add_u32 s33, s33, 36864
    s_cmp_eq_u32 s33, 151552
    s_cselect_b32 s33, 4096, s33
    s_waitcnt vmcnt(18)
    s_barrier
    s_mov_b32 s34, 0
k1_kernel_clloop:
    s_add_u32 s35, s24, s33
    s_mov_b32 m0, s35
    s_nop 0
    buffer_load_dwordx4 v14, s[12:15], s26 offen offset:0 sc1 lds
    buffer_load_dwordx4 v14, s[12:15], s26 offen offset:1024 sc1 lds
    buffer_load_dwordx4 v14, s[12:15], s26 offen offset:2048 sc1 lds
    buffer_load_dwordx4 v14, s[12:15], s26 offen offset:3072 sc1 lds
    s_add_u32 s36, s25, s33
    s_mov_b32 m0, s36
    s_add_u32 s37, s27, 4096
    buffer_load_dwordx4 v14, s[12:15], s27 offen offset:0 sc1 lds
    buffer_load_dwordx4 v14, s[12:15], s27 offen offset:1024 sc1 lds
    buffer_load_dwordx4 v14, s[12:15], s27 offen offset:2048 sc1 lds
    buffer_load_dwordx4 v14, s[12:15], s27 offen offset:3072 sc1 lds
    s_add_u32 s36, s36, 4096
    s_mov_b32 m0, s36
    s_nop 0
    buffer_load_dwordx4 v14, s[12:15], s37 offen sc1 lds
    s_add_u32 s26, s26, 16384
    s_add_u32 s27, s27, 20480
    s_add_u32 s33, s33, 36864
    s_cmp_eq_u32 s33, 151552
    s_cselect_b32 s33, 4096, s33
    s_lshl_b32 s38, s3, 8
    s_add_u32 s38, s38, s34
    s_cmp_eq_u32 s38, 13
    s_cbranch_scc1 k1_kernel_cyc
    s_cmp_lg_u32 s38, 10
    s_cbranch_scc1 k1_kernel_cl1
    s_mov_b32 s38, 0x2d30000
    buffer_load_dword v32, v30, s[12:15], s38 offen sc1
    s_mov_b32 s38, 0x2d32000
    buffer_load_dword v33, v30, s[12:15], s38 offen sc1
    s_mov_b32 s38, 0x2d34000
    buffer_load_dword v34, v30, s[12:15], s38 offen sc1
    s_mov_b32 s38, 0x2d36000
    buffer_load_dword v35, v30, s[12:15], s38 offen sc1
    s_waitcnt vmcnt(22)
    s_branch k1_kernel_cl2
k1_kernel_cl1:
    s_waitcnt vmcnt(18)
k1_kernel_cl2:
    s_barrier
    s_add_u32 s34, s34, 1
    s_cmp_lt_u32 s34, 14
    s_cbranch_scc1 k1_kernel_clloop
    s_branch k1_kernel_cyx
k1_kernel_cyc:
    s_mov_b32 s39, 0
k1_kernel_cy:
    v_and_b32 v32, v32, v33
    v_and_b32 v34, v34, v35
    v_and_b32 v32, v32, v34
    v_cmp_eq_u32 vcc, 1, v32
    s_nop 1
    v_cndmask_b32 v32, 0, 16, vcc
    v_cmp_gt_u32 vcc, 16, v32
    s_add_u32 s39, s39, 1
    s_cmp_gt_u32 s39, 20000
    s_cbranch_scc1 k1_kernel_cl1
    s_cbranch_vccz k1_kernel_cl1
    s_sleep 32
    s_mov_b32 s38, 0x2d30000
    buffer_load_dword v32, v30, s[12:15], s38 offen sc1
    s_mov_b32 s38, 0x2d32000
    buffer_load_dword v33, v30, s[12:15], s38 offen sc1
    s_mov_b32 s38, 0x2d34000
    buffer_load_dword v34, v30, s[12:15], s38 offen sc1
    s_mov_b32 s38, 0x2d36000
    buffer_load_dword v35, v30, s[12:15], s38 offen sc1
    s_waitcnt vmcnt(0)
    s_branch k1_kernel_cy
k1_kernel_cyx:
    v_lshrrev_b32 v3, 3, v2
    v_and_b32 v4, 7, v2
    v_lshlrev_b32 v4, 4, v4
    s_mul_i32 s33, s52, 144
    s_mul_i32 s34, s53, 80
    s_lshl_b32 s35, s22, 7
    s_add_u32 s35, s35, 0x2600000
    s_add_u32 s36, s3, 0
    s_lshl_b32 s37, s36, 3
    s_add_u32 s38, s37, s33
    s_add_u32 s38, s38, s34
    v_add_u32 v5, s38, v3
    v_lshl_add_u32 v5, v5, 12, v4
    s_lshl_b32 s36, s36, 10
    s_add_u32 s36, s36, 151552
    s_mov_b32 m0, s36
    s_nop 0
    buffer_load_dwordx4 v5, s[12:15], s35 offen sc1 lds
    s_add_u32 s36, s3, 4
    s_lshl_b32 s37, s36, 3
    s_add_u32 s38, s37, s33
    s_add_u32 s38, s38, s34
    v_add_u32 v5, s38, v3
    v_lshl_add_u32 v5, v5, 12, v4
    s_lshl_b32 s36, s36, 10
    s_add_u32 s36, s36, 151552
    s_mov_b32 m0, s36
    s_nop 0
    buffer_load_dwordx4 v5, s[12:15], s35 offen sc1 lds
    s_add_u32 s36, s3, 8
    s_min_u32 s36, s36, 9
    s_lshl_b32 s37, s36, 3
    s_add_u32 s38, s37, s33
    v_add_u32 v5, s38, v3
    v_lshl_add_u32 v5, v5, 12, v4
    s_lshl_b32 s36, s36, 10
    s_add_u32 s36, s36, 151552
    s_mov_b32 m0, s36
    s_nop 0
    buffer_load_dwordx4 v5, s[12:15], s35 offen sc1 lds
    v_and_b32 v3, 15, v2
    v_lshrrev_b32 v10, 4, v2
    v_mul_u32_u24 v13, 1152, v3
    v_lshl_add_u32 v13, v10, 3, v13
    v_lshlrev_b32 v12, 3, v3
    s_add_u32 s36, s54, 0
    s_lshr_b32 s37, s36, 2
    s_and_b32 s38, s36, 3
    s_mul_i32 s39, s53, 160
    s_lshl_b32 s40, s37, 5
    s_add_u32 s39, s39, s40
    s_lshl_b32 s40, s53, 1
    s_add_u32 s38, s38, s40
    s_and_b32 s38, s38, 3
    s_lshl_b32 s40, s22, 2
    s_add_u32 s40, s40, s38
    s_lshl_b32 s40, s40, 4
    s_mul_i32 s64, s40, 1152
    s_add_u32 s64, s64, s39
    s_mul_i32 s39, s52, 288
    s_add_u32 s64, s64, s39
    s_lshl_b32 s65, s37, 11
    s_lshl_b32 s39, s38, 5
    s_add_u32 s65, s65, s39
    s_add_u32 s65, s65, 151552
    s_lshl_b32 s66, s36, 10
    s_add_u32 s66, s66, 77824
    s_lshl_b32 s40, s40, 3
    s_add_u32 s40, s40, 0x2b00000
    buffer_load_dwordx2 v[200:201], v13, s[8:11], s64 offen
    buffer_load_dwordx2 v[208:209], v12, s[12:15], s40 offen sc1
    s_add_u32 s36, s54, 8
    s_lshr_b32 s37, s36, 2
    s_and_b32 s38, s36, 3
    s_mul_i32 s39, s53, 160
    s_lshl_b32 s40, s37, 5
    s_add_u32 s39, s39, s40
    s_lshl_b32 s40, s53, 1
    s_add_u32 s38, s38, s40
    s_and_b32 s38, s38, 3
    s_lshl_b32 s40, s22, 2
    s_add_u32 s40, s40, s38
    s_lshl_b32 s40, s40, 4
    s_mul_i32 s68, s40, 1152
    s_add_u32 s68, s68, s39
    s_mul_i32 s39, s52, 288
    s_add_u32 s68, s68, s39
    s_lshl_b32 s69, s37, 11
    s_lshl_b32 s39, s38, 5
    s_add_u32 s69, s69, s39
    s_add_u32 s69, s69, 151552
    s_lshl_b32 s70, s36, 10
    s_add_u32 s70, s70, 77824
    s_lshl_b32 s40, s40, 3
    s_add_u32 s40, s40, 0x2b00000
    buffer_load_dwordx2 v[202:203], v13, s[8:11], s68 offen
    buffer_load_dwordx2 v[210:211], v12, s[12:15], s40 offen sc1
    s_cmp_ge_u32 s54, 2
    s_cbranch_scc1 k1_kernel_fl0
    s_add_u32 s36, s54, 16
    s_mov_b32 s37, 4
    s_mov_b32 s38, s54
    s_mov_b32 s39, 128
    s_lshl_b32 s40, s53, 1
    s_add_u32 s38, s38, s40
    s_and_b32 s38, s38, 3
    s_lshl_b32 s40, s22, 2
    s_add_u32 s40, s40, s38
    s_lshl_b32 s40, s40, 4
    s_mul_i32 s72, s40, 1152
    s_add_u32 s72, s72, s39
    s_mul_i32 s39, s52, 288
    s_add_u32 s72, s72, s39
    s_lshl_b32 s73, s37, 11
    s_lshl_b32 s39, s38, 5
    s_add_u32 s73, s73, s39
    s_add_u32 s73, s73, 151552
    s_lshl_b32 s74, s36, 10
    s_add_u32 s74, s74, 77824
    s_lshl_b32 s40, s40, 3
    s_add_u32 s40, s40, 0x2b00000
    buffer_load_dwordx2 v[204:205], v13, s[8:11], s72 offen
    buffer_load_dwordx2 v[212:213], v12, s[12:15], s40 offen sc1
k1_kernel_fl0:
    s_waitcnt vmcnt(16)
    s_barrier
    s_waitcnt vmcnt(7)
    s_barrier
    s_barrier
    s_setprio 0
    s_waitcnt vmcnt(0)
    s_branch k1_kernel_cfin
k1_kernel_A1:
    s_setprio 2
    s_barrier
    s_cmp_lg_u32 s3, 0
    s_cbranch_scc1 k1_kernel_nosig
    v_mov_b32 v10, 1
    s_lshl_b32 s36, s22, 2
    v_mov_b32 v11, s36
    s_mov_b64 exec, 1
    buffer_atomic_add v10, v11, s[60:63], 0 offen sc1
    s_mov_b64 exec, -1
k1_kernel_nosig:
    s_add_u32 s86, s84, 0
    s_mov_b32 m0, s86
    s_add_u32 s87, s82, 384
    buffer_load_dwordx4 v204, s[28:31], s87 offen offset:0 lds
    buffer_load_dwordx4 v205, s[28:31], s87 offen offset:1024 lds
    buffer_load_dwordx4 v206, s[28:31], s87 offen offset:2048 lds
    buffer_load_dwordx4 v207, s[28:31], s87 offen offset:3072 lds
    s_add_u32 s86, s84, 16384
    s_mov_b32 m0, s86
    s_add_u32 s87, s83, 1769472
    buffer_load_dwordx4 v208, s[8:11], s87 offen offset:0 lds
    buffer_load_dwordx4 v209, s[8:11], s87 offen offset:1024 lds
    buffer_load_dwordx4 v210, s[8:11], s87 offen offset:2048 lds
    buffer_load_dwordx4 v211, s[8:11], s87 offen offset:3072 lds
    s_add_u32 s86, s85, 0
    s_mov_b32 m0, s86
    s_mov_b64 exec, 0xffffffff
    buffer_load_dwordx4 v212, s[8:11], s87 offen lds
    s_mov_b64 exec, -1
    s_mov_b32 s54, 0xbdd2d3e8
    s_mov_b32 s55, 0xbdd2d3e8
    s_mov_b32 s56, 0x3f800000
    s_mov_b32 s57, 0x3f800000
    v_mov_b32 v14, 0xc0135761
    v_mov_b32 v15, 0xc0135761
    s_lshl_b32 s36, s24, 9
    s_lshl_b32 s37, s25, 8
    s_add_u32 s38, s36, s37
    s_xor_b32 s37, s37, 256
    s_add_u32 s39, s36, s37
    v_lshlrev_b32 v10, 3, v3
    v_add_u32 v11, s38, v10
    ds_read_b64 v[100:101], v11 offset:0
    ds_read_b64 v[102:103], v11 offset:128
    v_add_u32 v11, s39, v10
    ds_read_b64 v[104:105], v11 offset:0
    ds_read_b64 v[106:107], v11 offset:128
    s_waitcnt lgkmcnt(0)
    v_mov_b32 v108, 0
    v_mov_b32 v109, 0
    v_mov_b32 v110, 0
    v_mov_b32 v111, 0
    v_mov_b32 v52, 0
    v_mov_b32 v53, 0
    v_mov_b32 v54, 0
    v_mov_b32 v55, 0
    s_call_b64 s[34:35], k1_kernel_gsub0
    v_dot2_f32_bf16 v108, v16, v236, v108
    v_dot2_f32_bf16 v109, v16, v16, v109
    v_dot2_f32_bf16 v110, v18, v236, v110
    v_dot2_f32_bf16 v111, v18, v18, v111
    v_dot2_f32_bf16 v52, v20, v236, v52
    v_dot2_f32_bf16 v53, v20, v20, v53
    v_dot2_f32_bf16 v54, v22, v236, v54
    v_dot2_f32_bf16 v55, v22, v22, v55
    v_dot2_f32_bf16 v108, v17, v236, v108
    v_dot2_f32_bf16 v109, v17, v17, v109
    v_dot2_f32_bf16 v110, v19, v236, v110
    v_dot2_f32_bf16 v111, v19, v19, v111
    v_dot2_f32_bf16 v52, v21, v236, v52
    v_dot2_f32_bf16 v53, v21, v21, v53
    v_dot2_f32_bf16 v54, v23, v236, v54
    v_dot2_f32_bf16 v55, v23, v23, v55
    s_barrier
    s_add_u32 s86, s84, 34816
    s_mov_b32 m0, s86
    s_add_u32 s87, s82, 512
    buffer_load_dwordx4 v204, s[28:31], s87 offen offset:0 lds
    buffer_load_dwordx4 v205, s[28:31], s87 offen offset:1024 lds
    buffer_load_dwordx4 v206, s[28:31], s87 offen offset:2048 lds
    buffer_load_dwordx4 v207, s[28:31], s87 offen offset:3072 lds
    s_add_u32 s86, s84, 51200
    s_mov_b32 m0, s86
    s_add_u32 s87, s83, 2359296
    buffer_load_dwordx4 v208, s[8:11], s87 offen offset:0 lds
    buffer_load_dwordx4 v209, s[8:11], s87 offen offset:1024 lds
    buffer_load_dwordx4 v210, s[8:11], s87 offen offset:2048 lds
    buffer_load_dwordx4 v211, s[8:11], s87 offen offset:3072 lds
    s_add_u32 s86, s85, 34816
    s_mov_b32 m0, s86
    s_mov_b64 exec, 0xffffffff
    buffer_load_dwordx4 v212, s[8:11], s87 offen lds
    s_mov_b64 exec, -1
    s_call_b64 s[34:35], k1_kernel_gsub1
    v_dot2_f32_bf16 v108, v24, v236, v108
    v_dot2_f32_bf16 v109, v24, v24, v109
    v_dot2_f32_bf16 v110, v26, v236, v110
    v_dot2_f32_bf16 v111, v26, v26, v111
    v_dot2_f32_bf16 v52, v28, v236, v52
    v_dot2_f32_bf16 v53, v28, v28, v53
    v_dot2_f32_bf16 v54, v30, v236, v54
    v_dot2_f32_bf16 v55, v30, v30, v55
    v_dot2_f32_bf16 v108, v25, v236, v108
    v_dot2_f32_bf16 v109, v25, v25, v109
    v_dot2_f32_bf16 v110, v27, v236, v110
    v_dot2_f32_bf16 v111, v27, v27, v111
    v_dot2_f32_bf16 v52, v29, v236, v52
    v_dot2_f32_bf16 v53, v29, v29, v53
    v_dot2_f32_bf16 v54, v31, v236, v54
    v_dot2_f32_bf16 v55, v31, v31, v55
    s_waitcnt vmcnt(9)
    s_barrier
    s_add_u32 s86, s84, 69632
    s_mov_b32 m0, s86
    s_add_u32 s87, s82, 640
    buffer_load_dwordx4 v204, s[28:31], s87 offen offset:0 lds
    buffer_load_dwordx4 v205, s[28:31], s87 offen offset:1024 lds
    buffer_load_dwordx4 v206, s[28:31], s87 offen offset:2048 lds
    buffer_load_dwordx4 v207, s[28:31], s87 offen offset:3072 lds
    s_add_u32 s86, s84, 86016
    s_mov_b32 m0, s86
    s_add_u32 s87, s83, 2949120
    buffer_load_dwordx4 v208, s[8:11], s87 offen offset:0 lds
    buffer_load_dwordx4 v209, s[8:11], s87 offen offset:1024 lds
    buffer_load_dwordx4 v210, s[8:11], s87 offen offset:2048 lds
    buffer_load_dwordx4 v211, s[8:11], s87 offen offset:3072 lds
    s_add_u32 s86, s85, 69632
    s_mov_b32 m0, s86
    s_mov_b64 exec, 0xffffffff
    buffer_load_dwordx4 v212, s[8:11], s87 offen lds
    s_mov_b64 exec, -1
    s_call_b64 s[34:35], k1_kernel_gsub2
    v_dot2_f32_bf16 v108, v32, v236, v108
    v_dot2_f32_bf16 v109, v32, v32, v109
    v_dot2_f32_bf16 v110, v34, v236, v110
    v_dot2_f32_bf16 v111, v34, v34, v111
    v_dot2_f32_bf16 v52, v36, v236, v52
    v_dot2_f32_bf16 v53, v36, v36, v53
    v_dot2_f32_bf16 v54, v38, v236, v54
    v_dot2_f32_bf16 v55, v38, v38, v55
    v_dot2_f32_bf16 v108, v33, v236, v108
    v_dot2_f32_bf16 v109, v33, v33, v109
    v_dot2_f32_bf16 v110, v35, v236, v110
    v_dot2_f32_bf16 v111, v35, v35, v111
    v_dot2_f32_bf16 v52, v37, v236, v52
    v_dot2_f32_bf16 v53, v37, v37, v53
    v_dot2_f32_bf16 v54, v39, v236, v54
    v_dot2_f32_bf16 v55, v39, v39, v55
    s_waitcnt vmcnt(9)
    s_barrier
    s_add_u32 s86, s84, 104448
    s_mov_b32 m0, s86
    s_add_u32 s87, s82, 768
    buffer_load_dwordx4 v204, s[28:31], s87 offen offset:0 lds
    buffer_load_dwordx4 v205, s[28:31], s87 offen offset:1024 lds
    buffer_load_dwordx4 v206, s[28:31], s87 offen offset:2048 lds
    buffer_load_dwordx4 v207, s[28:31], s87 offen offset:3072 lds
    s_add_u32 s86, s84, 120832
    s_mov_b32 m0, s86
    s_add_u32 s87, s83, 3538944
    buffer_load_dwordx4 v208, s[8:11], s87 offen offset:0 lds
    buffer_load_dwordx4 v209, s[8:11], s87 offen offset:1024 lds
    buffer_load_dwordx4 v210, s[8:11], s87 offen offset:2048 lds
    buffer_load_dwordx4 v211, s[8:11], s87 offen offset:3072 lds
    s_add_u32 s86, s85, 104448
    s_mov_b32 m0, s86
    s_mov_b64 exec, 0xffffffff
    buffer_load_dwordx4 v212, s[8:11], s87 offen lds
    s_mov_b64 exec, -1
    s_call_b64 s[34:35], k1_kernel_gsub3
    v_dot2_f32_bf16 v108, v40, v236, v108
    v_dot2_f32_bf16 v109, v40, v40, v109
    v_dot2_f32_bf16 v110, v42, v236, v110
    v_dot2_f32_bf16 v111, v42, v42, v111
    v_dot2_f32_bf16 v52, v44, v236, v52
    v_dot2_f32_bf16 v53, v44, v44, v53
    v_dot2_f32_bf16 v54, v46, v236, v54
    v_dot2_f32_bf16 v55, v46, v46, v55
    v_dot2_f32_bf16 v108, v41, v236, v108
    v_dot2_f32_bf16 v109, v41, v41, v109
    v_dot2_f32_bf16 v110, v43, v236, v110
    v_dot2_f32_bf16 v111, v43, v43, v111
    v_dot2_f32_bf16 v52, v45, v236, v52
    v_dot2_f32_bf16 v53, v45, v45, v53
    v_dot2_f32_bf16 v54, v47, v236, v54
    v_dot2_f32_bf16 v55, v47, v47, v55
    s_waitcnt vmcnt(9)
    s_barrier
    s_add_u32 s86, s84, 0
    s_mov_b32 m0, s86
    s_add_u32 s87, s82, 896
    buffer_load_dwordx4 v204, s[28:31], s87 offen offset:0 lds
    buffer_load_dwordx4 v205, s[28:31], s87 offen offset:1024 lds
    buffer_load_dwordx4 v206, s[28:31], s87 offen offset:2048 lds
    buffer_load_dwordx4 v207, s[28:31], s87 offen offset:3072 lds
    s_add_u32 s86, s84, 16384
    s_mov_b32 m0, s86
    s_add_u32 s87, s83, 4128768
    buffer_load_dwordx4 v208, s[8:11], s87 offen offset:0 lds
    buffer_load_dwordx4 v209, s[8:11], s87 offen offset:1024 lds
    buffer_load_dwordx4 v210, s[8:11], s87 offen offset:2048 lds
    buffer_load_dwordx4 v211, s[8:11], s87 offen offset:3072 lds
    s_add_u32 s86, s85, 0
    s_mov_b32 m0, s86
    s_mov_b64 exec, 0xffffffff
    buffer_load_dwordx4 v212, s[8:11], s87 offen lds
    s_mov_b64 exec, -1
    s_call_b64 s[34:35], k1_kernel_gsub4
    v_dot2_f32_bf16 v108, v48, v236, v108
    v_dot2_f32_bf16 v109, v48, v48, v109
    v_dot2_f32_bf16 v110, v50, v236, v110
    v_dot2_f32_bf16 v111, v50, v50, v111
    v_dot2_f32_bf16 v108, v49, v236, v108
    v_dot2_f32_bf16 v109, v49, v49, v109
    v_dot2_f32_bf16 v110, v51, v236, v110
    v_dot2_f32_bf16 v111, v51, v51, v111
    s_nop 2
    v_mov_b32 v72, v108
    v_mov_b32 v73, v110
    v_mov_b32 v74, v52
    v_mov_b32 v75, v54
    v_mov_b32 v76, v109
    v_mov_b32 v77, v111
    v_mov_b32 v78, v53
    v_mov_b32 v79, v55
    s_nop 1
    v_permlane32_swap_b32 v108, v72
    v_permlane32_swap_b32 v110, v73
    v_permlane32_swap_b32 v52, v74
    v_permlane32_swap_b32 v54, v75
    v_permlane32_swap_b32 v109, v76
    v_permlane32_swap_b32 v111, v77
    v_permlane32_swap_b32 v53, v78
    v_permlane32_swap_b32 v55, v79
    s_nop 1
    v_add_f32 v108, v108, v72
    v_add_f32 v110, v110, v73
    v_add_f32 v52, v52, v74
    v_add_f32 v54, v54, v75
    v_add_f32 v109, v109, v76
    v_add_f32 v111, v111, v77
    v_add_f32 v53, v53, v78
    v_add_f32 v55, v55, v79
    v_mov_b32 v72, v108
    v_mov_b32 v73, v110
    v_mov_b32 v74, v52
    v_mov_b32 v75, v54
    v_mov_b32 v76, v109
    v_mov_b32 v77, v111
    v_mov_b32 v78, v53
    v_mov_b32 v79, v55
    s_nop 1
    v_permlane16_swap_b32 v108, v72
    v_permlane16_swap_b32 v110, v73
    v_permlane16_swap_b32 v52, v74
    v_permlane16_swap_b32 v54, v75
    v_permlane16_swap_b32 v109, v76
    v_permlane16_swap_b32 v111, v77
    v_permlane16_swap_b32 v53, v78
    v_permlane16_swap_b32 v55, v79
    s_nop 1
    v_add_f32 v108, v108, v72
    v_add_f32 v110, v110, v73
    v_add_f32 v52, v52, v74
    v_add_f32 v54, v54, v75
    v_add_f32 v109, v109, v76
    v_add_f32 v111, v111, v77
    v_add_f32 v53, v53, v78
    v_add_f32 v55, v55, v79
    v_lshrrev_b32 v10, 4, v2
    v_cmp_eq_u32 vcc, 1, v10
    s_nop 1
    v_cndmask_b32 v108, v108, v110, vcc
    v_cndmask_b32 v109, v109, v111, vcc
    v_cmp_eq_u32 vcc, 2, v10
    s_nop 1
    v_cndmask_b32 v108, v108, v52, vcc
    v_cndmask_b32 v109, v109, v53, vcc
    v_cmp_eq_u32 vcc, 3, v10
    s_nop 1
    v_cndmask_b32 v108, v108, v54, vcc
    v_cndmask_b32 v109, v109, v55, vcc
    v_and_b32 v109, 0x7fffffff, v109
    buffer_store_dwordx2 v[108:109], v94, s[12:15], s58 offen sc1
    s_waitcnt vmcnt(10)
    s_barrier
    s_add_u32 s86, s84, 34816
    s_mov_b32 m0, s86
    s_add_u32 s87, s82, 1024
    buffer_load_dwordx4 v204, s[28:31], s87 offen offset:0 lds
    buffer_load_dwordx4 v205, s[28:31], s87 offen offset:1024 lds
    buffer_load_dwordx4 v206, s[28:31], s87 offen offset:2048 lds
    buffer_load_dwordx4 v207, s[28:31], s87 offen offset:3072 lds
    s_add_u32 s86, s84, 51200
    s_mov_b32 m0, s86
    s_add_u32 s87, s83, 4718592
    buffer_load_dwordx4 v208, s[8:11], s87 offen offset:0 lds
    buffer_load_dwordx4 v209, s[8:11], s87 offen offset:1024 lds
    buffer_load_dwordx4 v210, s[8:11], s87 offen offset:2048 lds
    buffer_load_dwordx4 v211, s[8:11], s87 offen offset:3072 lds
    s_add_u32 s86, s85, 34816
    s_mov_b32 m0, s86
    s_mov_b64 exec, 0xffffffff
    buffer_load_dwordx4 v212, s[8:11], s87 offen lds
    s_mov_b64 exec, -1
    s_mov_b32 s92, s78
    s_and_b32 s93, s79, 0xffff
    s_mov_b32 s94, 0x800000
    s_mov_b32 s95, 0x00020000
    v_lshrrev_b32 v10, 4, v2
    v_lshlrev_b32 v10, 12, v10
    v_lshl_add_u32 v10, v3, 4, v10
    s_lshl_b32 s40, s22, 7
    s_lshl_b32 s36, s3, 5
    s_add_u32 s40, s40, s36
    s_lshl_b32 s40, s40, 12
    s_lshl_b32 s36, s23, 8
    s_add_u32 s40, s40, s36
    buffer_load_dwordx4 v[200:203], v10, s[92:95], s40 offen
    s_add_u32 s40, s40, 16384
    buffer_load_dwordx4 v[200:203], v10, s[92:95], s40 offen
    s_add_u32 s40, s40, 16384
    buffer_load_dwordx4 v[200:203], v10, s[92:95], s40 offen
    s_add_u32 s40, s40, 16384
    buffer_load_dwordx4 v[200:203], v10, s[92:95], s40 offen
    s_add_u32 s40, s40, 16384
    buffer_load_dwordx4 v[200:203], v10, s[92:95], s40 offen
    s_add_u32 s40, s40, 16384
    buffer_load_dwordx4 v[200:203], v10, s[92:95], s40 offen
    s_add_u32 s40, s40, 16384
    buffer_load_dwordx4 v[200:203], v10, s[92:95], s40 offen
    s_add_u32 s40, s40, 16384
    buffer_load_dwordx4 v[200:203], v10, s[92:95], s40 offen
    s_lshl_b32 s36, s22, 2
    v_mov_b32 v199, s36
    buffer_load_dword v198, v199, s[60:63], 0 offen sc1
    s_waitcnt vmcnt(18)
    s_barrier
    s_waitcnt vmcnt(9)
    s_barrier
    s_barrier
    s_barrier
    s_load_dwordx4 s[88:91], s[0:1], 32
    v_and_b32 v4, 31, v2
    v_lshlrev_b32 v4, 4, v4
    v_lshrrev_b32 v10, 5, v2
    v_lshl_add_u32 v4, v10, 10, v4
    s_add_u32 s52, s59, 0
    s_add_u32 s53, s59, 4096
    s_add_u32 s42, s59, 8192
    s_add_u32 s43, s59, 12288
    s_add_u32 s40, s59, 16384
    s_add_u32 s41, s59, 20480
    s_add_u32 s38, s59, 24576
    s_add_u32 s39, s59, 28672
    s_waitcnt vmcnt(0)
    buffer_load_dwordx4 v[128:131], v4, s[12:15], s52 offen offset:0 sc1
    buffer_load_dwordx4 v[132:135], v4, s[12:15], s52 offen offset:2048 sc1
    buffer_load_dwordx4 v[136:139], v4, s[12:15], s53 offen offset:0 sc1
    buffer_load_dwordx4 v[140:143], v4, s[12:15], s53 offen offset:2048 sc1
    buffer_load_dwordx4 v[144:147], v4, s[12:15], s42 offen offset:0 sc1
    buffer_load_dwordx4 v[148:151], v4, s[12:15], s42 offen offset:2048 sc1
    buffer_load_dwordx4 v[152:155], v4, s[12:15], s43 offen offset:0 sc1
    buffer_load_dwordx4 v[156:159], v4, s[12:15], s43 offen offset:2048 sc1
    buffer_load_dwordx4 v[160:163], v4, s[12:15], s40 offen offset:0 sc1
    buffer_load_dwordx4 v[164:167], v4, s[12:15], s40 offen offset:2048 sc1
    buffer_load_dwordx4 v[168:171], v4, s[12:15], s41 offen offset:0 sc1
    buffer_load_dwordx4 v[172:175], v4, s[12:15], s41 offen offset:2048 sc1
    buffer_load_dwordx4 v[176:179], v4, s[12:15], s38 offen offset:0 sc1
    buffer_load_dwordx4 v[180:183], v4, s[12:15], s38 offen offset:2048 sc1
    buffer_load_dwordx4 v[184:187], v4, s[12:15], s39 offen offset:0 sc1
    buffer_load_dwordx4 v[188:191], v4, s[12:15], s39 offen offset:2048 sc1
    s_mov_b32 s33, 0
    s_waitcnt vmcnt(0)
k1_kernel_chk:
    v_subrev_u32 v11, 16, v198
    v_or3_b32 v11, v11, v129, v131
    v_or3_b32 v11, v11, v133, v135
    v_or3_b32 v11, v11, v137, v139
    v_or3_b32 v11, v11, v141, v143
    v_or3_b32 v11, v11, v145, v147
    v_or3_b32 v11, v11, v149, v151
    v_or3_b32 v11, v11, v153, v155
    v_or3_b32 v11, v11, v157, v159
    v_or3_b32 v11, v11, v161, v163
    v_or3_b32 v11, v11, v165, v167
    v_or3_b32 v11, v11, v169, v171
    v_or3_b32 v11, v11, v173, v175
    v_or3_b32 v11, v11, v177, v179
    v_or3_b32 v11, v11, v181, v183
    v_or3_b32 v11, v11, v185, v187
    v_or3_b32 v11, v11, v189, v191
    v_cmp_gt_i32 vcc, 0, v11
    s_add_u32 s33, s33, 1
    s_cmp_gt_u32 s33, 20000
    s_cbranch_scc1 k1_kernel_ok
    s_cbranch_vccz k1_kernel_ok
    s_sleep 32
    buffer_load_dword v198, v199, s[60:63], 0 offen sc1
    s_waitcnt vmcnt(0)
    buffer_load_dwordx4 v[128:131], v4, s[12:15], s52 offen offset:0 sc1
    buffer_load_dwordx4 v[132:135], v4, s[12:15], s52 offen offset:2048 sc1
    buffer_load_dwordx4 v[136:139], v4, s[12:15], s53 offen offset:0 sc1
    buffer_load_dwordx4 v[140:143], v4, s[12:15], s53 offen offset:2048 sc1
    buffer_load_dwordx4 v[144:147], v4, s[12:15], s42 offen offset:0 sc1
    buffer_load_dwordx4 v[148:151], v4, s[12:15], s42 offen offset:2048 sc1
    buffer_load_dwordx4 v[152:155], v4, s[12:15], s43 offen offset:0 sc1
    buffer_load_dwordx4 v[156:159], v4, s[12:15], s43 offen offset:2048 sc1
    buffer_load_dwordx4 v[160:163], v4, s[12:15], s40 offen offset:0 sc1
    buffer_load_dwordx4 v[164:167], v4, s[12:15], s40 offen offset:2048 sc1
    buffer_load_dwordx4 v[168:171], v4, s[12:15], s41 offen offset:0 sc1
    buffer_load_dwordx4 v[172:175], v4, s[12:15], s41 offen offset:2048 sc1
    buffer_load_dwordx4 v[176:179], v4, s[12:15], s38 offen offset:0 sc1
    buffer_load_dwordx4 v[180:183], v4, s[12:15], s38 offen offset:2048 sc1
    buffer_load_dwordx4 v[184:187], v4, s[12:15], s39 offen offset:0 sc1
    buffer_load_dwordx4 v[188:191], v4, s[12:15], s39 offen offset:2048 sc1
    s_waitcnt vmcnt(0)
    s_branch k1_kernel_chk
k1_kernel_ok:
    v_pk_add_f32 v[128:129], v[128:129], v[160:161]
    v_pk_add_f32 v[130:131], v[130:131], v[162:163]
    v_pk_add_f32 v[132:133], v[132:133], v[164:165]
    v_pk_add_f32 v[134:135], v[134:135], v[166:167]
    v_pk_add_f32 v[136:137], v[136:137], v[168:169]
    v_pk_add_f32 v[138:139], v[138:139], v[170:171]
    v_pk_add_f32 v[140:141], v[140:141], v[172:173]
    v_pk_add_f32 v[142:143], v[142:143], v[174:175]
    v_pk_add_f32 v[144:145], v[144:145], v[176:177]
    v_pk_add_f32 v[146:147], v[146:147], v[178:179]
    v_pk_add_f32 v[148:149], v[148:149], v[180:181]
    v_pk_add_f32 v[150:151], v[150:151], v[182:183]
    v_pk_add_f32 v[152:153], v[152:153], v[184:185]
    v_pk_add_f32 v[154:155], v[154:155], v[186:187]
    v_pk_add_f32 v[156:157], v[156:157], v[188:189]
    v_pk_add_f32 v[158:159], v[158:159], v[190:191]
    v_pk_add_f32 v[128:129], v[128:129], v[144:145]
    v_pk_add_f32 v[130:131], v[130:131], v[146:147]
    v_pk_add_f32 v[132:133], v[132:133], v[148:149]
    v_pk_add_f32 v[134:135], v[134:135], v[150:151]
    v_pk_add_f32 v[136:137], v[136:137], v[152:153]
    v_pk_add_f32 v[138:139], v[138:139], v[154:155]
    v_pk_add_f32 v[140:141], v[140:141], v[156:157]
    v_pk_add_f32 v[142:143], v[142:143], v[158:159]
    v_pk_add_f32 v[128:129], v[128:129], v[136:137]
    v_pk_add_f32 v[130:131], v[130:131], v[138:139]
    v_pk_add_f32 v[132:133], v[132:133], v[140:141]
    v_pk_add_f32 v[134:135], v[134:135], v[142:143]
    v_pk_add_f32 v[128:129], v[128:129], v[132:133]
    v_pk_add_f32 v[130:131], v[130:131], v[134:135]
    v_mov_b32 v72, v128
    v_mov_b32 v73, v129
    v_mov_b32 v74, v130
    v_mov_b32 v75, v131
    s_nop 1
    v_permlane32_swap_b32 v128, v72
    v_permlane32_swap_b32 v129, v73
    v_permlane32_swap_b32 v130, v74
    v_permlane32_swap_b32 v131, v75
    s_nop 1
    v_add_f32 v128, v128, v72
    v_add_f32 v129, v129, v73
    v_add_f32 v130, v130, v74
    v_add_f32 v131, v131, v75
    v_mul_f32 v136, 0x39e38e39, v128
    v_mul_f32 v132, 0x39e38e39, v129
    v_fma_f32 v132, -v136, v136, v132
    v_max_f32 v132, 0, v132
    v_cvt_pk_bf16_f32 v140, v136, v132
    v_lshlrev_b32 v136, 16, v140
    v_and_b32 v132, 0xffff0000, v140
    v_add_f32 v132, 0x3727c5ac, v132
    v_cvt_pk_bf16_f32 v140, v132, v132
    v_lshlrev_b32 v132, 16, v140
    v_sqrt_f32 v132, v132
    s_nop 0
    v_cvt_pk_bf16_f32 v140, v132, v132
    v_lshlrev_b32 v132, 16, v140
    v_rcp_f32 v132, v132
    s_nop 0
    v_mul_f32 v133, -v136, v132
    v_mul_f32 v137, 0x39e38e39, v130
    v_mul_f32 v134, 0x39e38e39, v131
    v_fma_f32 v134, -v137, v137, v134
    v_max_f32 v134, 0, v134
    v_cvt_pk_bf16_f32 v140, v137, v134
    v_lshlrev_b32 v137, 16, v140
    v_and_b32 v134, 0xffff0000, v140
    v_add_f32 v134, 0x3727c5ac, v134
    v_cvt_pk_bf16_f32 v140, v134, v134
    v_lshlrev_b32 v134, 16, v140
    v_sqrt_f32 v134, v134
    s_nop 0
    v_cvt_pk_bf16_f32 v140, v134, v134
    v_lshlrev_b32 v134, 16, v140
    v_rcp_f32 v134, v134
    s_nop 0
    v_mul_f32 v135, -v137, v134
    v_and_b32 v10, 31, v2
    s_lshl_b32 s36, s24, 9
    v_lshl_add_u32 v10, v10, 4, s36
    ds_write_b128 v10, v[132:135] offset:1024
    s_lshl_b32 s37, s25, 8
    s_add_u32 s38, s36, s37
    s_xor_b32 s37, s37, 256
    s_add_u32 s39, s36, s37
    v_lshlrev_b32 v10, 3, v3
    v_add_u32 v11, s38, v10
    v_add_u32 v10, s39, v10
    s_waitcnt lgkmcnt(0)
    ds_read_b64 v[100:101], v11 offset:1024
    ds_read_b64 v[102:103], v11 offset:1152
    ds_read_b64 v[104:105], v10 offset:1024
    ds_read_b64 v[106:107], v10 offset:1152
    v_lshrrev_b32 v10, 4, v2
    v_lshrrev_b32 v11, 2, v2
    v_and_b32 v11, 1, v11
    v_lshlrev_b32 v11, 4, v11
    v_lshrrev_b32 v5, 3, v2
    v_and_b32 v5, 1, v5
    v_lshl_add_u32 v11, v5, 2, v11
    v_and_b32 v5, 3, v2
    v_add_u32 v11, v11, v5
    v_and_b32 v5, 1, v10
    v_lshl_add_u32 v11, v5, 3, v11
    v_lshlrev_b32 v11, 5, v11
    v_lshrrev_b32 v5, 1, v10
    v_lshl_add_u32 v6, v5, 4, v11
    s_lshl_b32 s33, s23, 5
    s_lshl_b32 s36, s22, 1
    s_add_u32 s33, s33, s36
    s_add_u32 s33, s33, s24
    s_mul_i32 s33, s33, 18432
    s_lshl_b32 s36, s25, 10
    s_add_u32 s39, s33, s36
    s_add_u32 s39, s39, 8192
    s_mul_i32 s38, s25, 10240
    s_add_u32 s33, s33, s38
    s_add_u32 s37, s33, s36
    s_xor_b32 s36, s36, 1024
    s_add_u32 s38, s33, s36
    s_add_u32 s33, s37, 4096
    s_add_u32 s36, s38, 4096
    s_waitcnt lgkmcnt(0)
    v_lshlrev_b32 v72, 16, v16
    v_and_b32 v73, 0xffff0000, v16
    v_lshlrev_b32 v74, 16, v17
    v_and_b32 v75, 0xffff0000, v17
    v_lshlrev_b32 v76, 16, v18
    v_and_b32 v77, 0xffff0000, v18
    v_lshlrev_b32 v78, 16, v19
    v_and_b32 v79, 0xffff0000, v19
    v_pk_fma_f32 v[72:73], v[72:73], v[100:101], v[100:101] op_sel:[0,0,1] op_sel_hi:[1,0,1]
    v_pk_fma_f32 v[74:75], v[74:75], v[100:101], v[100:101] op_sel:[0,0,1] op_sel_hi:[1,0,1]
    v_pk_fma_f32 v[76:77], v[76:77], v[102:103], v[102:103] op_sel:[0,0,1] op_sel_hi:[1,0,1]
    v_pk_fma_f32 v[78:79], v[78:79], v[102:103], v[102:103] op_sel:[0,0,1] op_sel_hi:[1,0,1]
    v_cvt_pk_bf16_f32 v200, v72, v73
    v_cvt_pk_bf16_f32 v201, v74, v75
    v_cvt_pk_bf16_f32 v202, v76, v77
    v_cvt_pk_bf16_f32 v203, v78, v79
    s_nop 1
    v_permlane16_swap_b32 v200, v202
    v_permlane16_swap_b32 v201, v203
    s_nop 0
    buffer_store_dwordx4 v[200:203], v6, s[12:15], s37 offen offset:0 sc1
    v_lshlrev_b32 v72, 16, v20
    v_and_b32 v73, 0xffff0000, v20
    v_lshlrev_b32 v74, 16, v21
    v_and_b32 v75, 0xffff0000, v21
    v_lshlrev_b32 v76, 16, v22
    v_and_b32 v77, 0xffff0000, v22
    v_lshlrev_b32 v78, 16, v23
    v_and_b32 v79, 0xffff0000, v23
    v_pk_fma_f32 v[72:73], v[72:73], v[104:105], v[104:105] op_sel:[0,0,1] op_sel_hi:[1,0,1]
    v_pk_fma_f32 v[74:75], v[74:75], v[104:105], v[104:105] op_sel:[0,0,1] op_sel_hi:[1,0,1]
    v_pk_fma_f32 v[76:77], v[76:77], v[106:107], v[106:107] op_sel:[0,0,1] op_sel_hi:[1,0,1]
    v_pk_fma_f32 v[78:79], v[78:79], v[106:107], v[106:107] op_sel:[0,0,1] op_sel_hi:[1,0,1]
    v_cvt_pk_bf16_f32 v204, v72, v73
    v_cvt_pk_bf16_f32 v205, v74, v75
    v_cvt_pk_bf16_f32 v206, v76, v77
    v_cvt_pk_bf16_f32 v207, v78, v79
    s_nop 1
    v_permlane16_swap_b32 v204, v206
    v_permlane16_swap_b32 v205, v207
    s_nop 0
    buffer_store_dwordx4 v[204:207], v6, s[12:15], s38 offen offset:0 sc1
    v_lshlrev_b32 v72, 16, v24
    v_and_b32 v73, 0xffff0000, v24
    v_lshlrev_b32 v74, 16, v25
    v_and_b32 v75, 0xffff0000, v25
    v_lshlrev_b32 v76, 16, v26
    v_and_b32 v77, 0xffff0000, v26
    v_lshlrev_b32 v78, 16, v27
    v_and_b32 v79, 0xffff0000, v27
    v_pk_fma_f32 v[72:73], v[72:73], v[100:101], v[100:101] op_sel:[0,0,1] op_sel_hi:[1,0,1]
    v_pk_fma_f32 v[74:75], v[74:75], v[100:101], v[100:101] op_sel:[0,0,1] op_sel_hi:[1,0,1]
    v_pk_fma_f32 v[76:77], v[76:77], v[102:103], v[102:103] op_sel:[0,0,1] op_sel_hi:[1,0,1]
    v_pk_fma_f32 v[78:79], v[78:79], v[102:103], v[102:103] op_sel:[0,0,1] op_sel_hi:[1,0,1]
    v_cvt_pk_bf16_f32 v208, v72, v73
    v_cvt_pk_bf16_f32 v209, v74, v75
    v_cvt_pk_bf16_f32 v210, v76, v77
    v_cvt_pk_bf16_f32 v211, v78, v79
    s_nop 1
    v_permlane16_swap_b32 v208, v210
    v_permlane16_swap_b32 v209, v211
    s_nop 0
    buffer_store_dwordx4 v[208:211], v6, s[12:15], s37 offen offset:2048 sc1
    v_lshlrev_b32 v72, 16, v28
    v_and_b32 v73, 0xffff0000, v28
    v_lshlrev_b32 v74, 16, v29
    v_and_b32 v75, 0xffff0000, v29
    v_lshlrev_b32 v76, 16, v30
    v_and_b32 v77, 0xffff0000, v30
    v_lshlrev_b32 v78, 16, v31
    v_and_b32 v79, 0xffff0000, v31
    v_pk_fma_f32 v[72:73], v[72:73], v[104:105], v[104:105] op_sel:[0,0,1] op_sel_hi:[1,0,1]
    v_pk_fma_f32 v[74:75], v[74:75], v[104:105], v[104:105] op_sel:[0,0,1] op_sel_hi:[1,0,1]
    v_pk_fma_f32 v[76:77], v[76:77], v[106:107], v[106:107] op_sel:[0,0,1] op_sel_hi:[1,0,1]
    v_pk_fma_f32 v[78:79], v[78:79], v[106:107], v[106:107] op_sel:[0,0,1] op_sel_hi:[1,0,1]
    v_cvt_pk_bf16_f32 v212, v72, v73
    v_cvt_pk_bf16_f32 v213, v74, v75
    v_cvt_pk_bf16_f32 v214, v76, v77
    v_cvt_pk_bf16_f32 v215, v78, v79
    s_nop 1
    v_permlane16_swap_b32 v212, v214
    v_permlane16_swap_b32 v213, v215
    s_nop 0
    buffer_store_dwordx4 v[212:215], v6, s[12:15], s38 offen offset:2048 sc1
    v_lshlrev_b32 v72, 16, v32
    v_and_b32 v73, 0xffff0000, v32
    v_lshlrev_b32 v74, 16, v33
    v_and_b32 v75, 0xffff0000, v33
    v_lshlrev_b32 v76, 16, v34
    v_and_b32 v77, 0xffff0000, v34
    v_lshlrev_b32 v78, 16, v35
    v_and_b32 v79, 0xffff0000, v35
    v_pk_fma_f32 v[72:73], v[72:73], v[100:101], v[100:101] op_sel:[0,0,1] op_sel_hi:[1,0,1]
    v_pk_fma_f32 v[74:75], v[74:75], v[100:101], v[100:101] op_sel:[0,0,1] op_sel_hi:[1,0,1]
    v_pk_fma_f32 v[76:77], v[76:77], v[102:103], v[102:103] op_sel:[0,0,1] op_sel_hi:[1,0,1]
    v_pk_fma_f32 v[78:79], v[78:79], v[102:103], v[102:103] op_sel:[0,0,1] op_sel_hi:[1,0,1]
    v_cvt_pk_bf16_f32 v216, v72, v73
    v_cvt_pk_bf16_f32 v217, v74, v75
    v_cvt_pk_bf16_f32 v218, v76, v77
    v_cvt_pk_bf16_f32 v219, v78, v79
    s_nop 1
    v_permlane16_swap_b32 v216, v218
    v_permlane16_swap_b32 v217, v219
    s_nop 0
    buffer_store_dwordx4 v[216:219], v6, s[12:15], s33 offen offset:0 sc1
    v_lshlrev_b32 v72, 16, v36
    v_and_b32 v73, 0xffff0000, v36
    v_lshlrev_b32 v74, 16, v37
    v_and_b32 v75, 0xffff0000, v37
    v_lshlrev_b32 v76, 16, v38
    v_and_b32 v77, 0xffff0000, v38
    v_lshlrev_b32 v78, 16, v39
    v_and_b32 v79, 0xffff0000, v39
    v_pk_fma_f32 v[72:73], v[72:73], v[104:105], v[104:105] op_sel:[0,0,1] op_sel_hi:[1,0,1]
    v_pk_fma_f32 v[74:75], v[74:75], v[104:105], v[104:105] op_sel:[0,0,1] op_sel_hi:[1,0,1]
    v_pk_fma_f32 v[76:77], v[76:77], v[106:107], v[106:107] op_sel:[0,0,1] op_sel_hi:[1,0,1]
    v_pk_fma_f32 v[78:79], v[78:79], v[106:107], v[106:107] op_sel:[0,0,1] op_sel_hi:[1,0,1]
    v_cvt_pk_bf16_f32 v220, v72, v73
    v_cvt_pk_bf16_f32 v221, v74, v75
    v_cvt_pk_bf16_f32 v222, v76, v77
    v_cvt_pk_bf16_f32 v223, v78, v79
    s_nop 1
    v_permlane16_swap_b32 v220, v222
    v_permlane16_swap_b32 v221, v223
    s_nop 0
    buffer_store_dwordx4 v[220:223], v6, s[12:15], s36 offen offset:0 sc1
    v_lshlrev_b32 v72, 16, v40
    v_and_b32 v73, 0xffff0000, v40
    v_lshlrev_b32 v74, 16, v41
    v_and_b32 v75, 0xffff0000, v41
    v_lshlrev_b32 v76, 16, v42
    v_and_b32 v77, 0xffff0000, v42
    v_lshlrev_b32 v78, 16, v43
    v_and_b32 v79, 0xffff0000, v43
    v_pk_fma_f32 v[72:73], v[72:73], v[100:101], v[100:101] op_sel:[0,0,1] op_sel_hi:[1,0,1]
    v_pk_fma_f32 v[74:75], v[74:75], v[100:101], v[100:101] op_sel:[0,0,1] op_sel_hi:[1,0,1]
    v_pk_fma_f32 v[76:77], v[76:77], v[102:103], v[102:103] op_sel:[0,0,1] op_sel_hi:[1,0,1]
    v_pk_fma_f32 v[78:79], v[78:79], v[102:103], v[102:103] op_sel:[0,0,1] op_sel_hi:[1,0,1]
    v_cvt_pk_bf16_f32 v224, v72, v73
    v_cvt_pk_bf16_f32 v225, v74, v75
    v_cvt_pk_bf16_f32 v226, v76, v77
    v_cvt_pk_bf16_f32 v227, v78, v79
    s_nop 1
    v_permlane16_swap_b32 v224, v226
    v_permlane16_swap_b32 v225, v227
    s_nop 0
    buffer_store_dwordx4 v[224:227], v6, s[12:15], s33 offen offset:2048 sc1
    v_lshlrev_b32 v72, 16, v44
    v_and_b32 v73, 0xffff0000, v44
    v_lshlrev_b32 v74, 16, v45
    v_and_b32 v75, 0xffff0000, v45
    v_lshlrev_b32 v76, 16, v46
    v_and_b32 v77, 0xffff0000, v46
    v_lshlrev_b32 v78, 16, v47
    v_and_b32 v79, 0xffff0000, v47
    v_pk_fma_f32 v[72:73], v[72:73], v[104:105], v[104:105] op_sel:[0,0,1] op_sel_hi:[1,0,1]
    v_pk_fma_f32 v[74:75], v[74:75], v[104:105], v[104:105] op_sel:[0,0,1] op_sel_hi:[1,0,1]
    v_pk_fma_f32 v[76:77], v[76:77], v[106:107], v[106:107] op_sel:[0,0,1] op_sel_hi:[1,0,1]
    v_pk_fma_f32 v[78:79], v[78:79], v[106:107], v[106:107] op_sel:[0,0,1] op_sel_hi:[1,0,1]
    v_cvt_pk_bf16_f32 v228, v72, v73
    v_cvt_pk_bf16_f32 v229, v74, v75
    v_cvt_pk_bf16_f32 v230, v76, v77
    v_cvt_pk_bf16_f32 v231, v78, v79
    s_nop 1
    v_permlane16_swap_b32 v228, v230
    v_permlane16_swap_b32 v229, v231
    s_nop 0
    buffer_store_dwordx4 v[228:231], v6, s[12:15], s36 offen offset:2048 sc1
    v_lshlrev_b32 v72, 16, v48
    v_and_b32 v73, 0xffff0000, v48
    v_lshlrev_b32 v74, 16, v49
    v_and_b32 v75, 0xffff0000, v49
    v_lshlrev_b32 v76, 16, v50
    v_and_b32 v77, 0xffff0000, v50
    v_lshlrev_b32 v78, 16, v51
    v_and_b32 v79, 0xffff0000, v51
    v_pk_fma_f32 v[72:73], v[72:73], v[100:101], v[100:101] op_sel:[0,0,1] op_sel_hi:[1,0,1]
    v_pk_fma_f32 v[74:75], v[74:75], v[100:101], v[100:101] op_sel:[0,0,1] op_sel_hi:[1,0,1]
    v_pk_fma_f32 v[76:77], v[76:77], v[102:103], v[102:103] op_sel:[0,0,1] op_sel_hi:[1,0,1]
    v_pk_fma_f32 v[78:79], v[78:79], v[102:103], v[102:103] op_sel:[0,0,1] op_sel_hi:[1,0,1]
    v_cvt_pk_bf16_f32 v232, v72, v73
    v_cvt_pk_bf16_f32 v233, v74, v75
    v_cvt_pk_bf16_f32 v234, v76, v77
    v_cvt_pk_bf16_f32 v235, v78, v79
    s_nop 1
    v_permlane16_swap_b32 v232, v234
    v_permlane16_swap_b32 v233, v235
    s_nop 0
    buffer_store_dwordx4 v[232:235], v6, s[12:15], s39 offen sc1
    s_setprio 3
    s_mov_b32 s8, s78
    s_and_b32 s9, s79, 0xffff
    s_mov_b32 s10, 0x800000
    s_mov_b32 s11, 0x00020000
    v_lshrrev_b32 v3, 3, v2
    s_lshl_b32 s24, s3, 5
    v_add_u32 v3, s24, v3
    v_and_b32 v4, 7, v2
    v_lshrrev_b32 v6, 4, v2
    v_xor_b32 v6, v6, v4
    v_lshlrev_b32 v6, 4, v6
    v_lshl_add_u32 v10, v3, 12, v6
    v_xor_b32 v11, 64, v10
    v_add_u32 v11, 31744, v11
    v_add_u32 v12, 63488, v10
    v_add_u32 v13, 63488, v11
    v_lshlrev_b32 v14, 4, v2
    s_lshl_b32 s26, s22, 19
    s_mul_i32 s27, s23, 589824
    s_lshl_b32 s24, s3, 12
    s_add_u32 s27, s27, s24
    s_lshl_b32 s25, s3, 9
    s_sub_u32 s32, s25, s24
    s_add_u32 s32, s32, 16384
    s_add_u32 s24, s24, 4096
    s_waitcnt vmcnt(0) lgkmcnt(0)
    v_mov_b32 v26, 2048
    v_mov_b32 v27, 1
    s_mov_b64 exec, 1
    ds_add_rtn_u32 v28, v26, v27
    s_waitcnt lgkmcnt(0)
    v_readfirstlane_b32 s36, v28
    s_cmp_lg_u32 s36, 3
    s_cbranch_scc1 k1_kernel_nozs
    v_mov_b32 v28, 0
    buffer_store_dword v27, v28, s[12:15], s97 offen sc1
k1_kernel_nozs:
    s_mov_b64 exec, -1
    s_mov_b32 s16, s88
    s_and_b32 s17, s89, 0xffff
    s_mov_b32 s18, 0x240000
    s_mov_b32 s19, 0x00020000
    s_mov_b32 s84, s90
    s_and_b32 s85, s91, 0xffff
    s_mov_b32 s86, 0x480
    s_mov_b32 s87, 0x00020000
    s_add_u32 s35, s24, 0
    s_mov_b32 m0, s35
    s_add_u32 s36, s26, 0
    buffer_load_dwordx4 v10, s[8:11], s36 offen offset:0 lds
    buffer_load_dwordx4 v11, s[8:11], s36 offen offset:1024 lds
    buffer_load_dwordx4 v12, s[8:11], s36 offen offset:2048 lds
    buffer_load_dwordx4 v13, s[8:11], s36 offen offset:3072 lds
    s_add_u32 s35, s24, 34816
    s_mov_b32 m0, s35
    s_add_u32 s36, s26, 128
    buffer_load_dwordx4 v10, s[8:11], s36 offen offset:0 lds
    buffer_load_dwordx4 v11, s[8:11], s36 offen offset:1024 lds
    buffer_load_dwordx4 v12, s[8:11], s36 offen offset:2048 lds
    buffer_load_dwordx4 v13, s[8:11], s36 offen offset:3072 lds
    s_add_u32 s35, s24, 69632
    s_mov_b32 m0, s35
    s_add_u32 s36, s26, 256
    buffer_load_dwordx4 v10, s[8:11], s36 offen offset:0 lds
    buffer_load_dwordx4 v11, s[8:11], s36 offen offset:1024 lds
    buffer_load_dwordx4 v12, s[8:11], s36 offen offset:2048 lds
    buffer_load_dwordx4 v13, s[8:11], s36 offen offset:3072 lds
    s_add_u32 s35, s24, 104448
    s_mov_b32 m0, s35
    s_add_u32 s36, s26, 384
    buffer_load_dwordx4 v10, s[8:11], s36 offen offset:0 lds
    buffer_load_dwordx4 v11, s[8:11], s36 offen offset:1024 lds
    buffer_load_dwordx4 v12, s[8:11], s36 offen offset:2048 lds
    buffer_load_dwordx4 v13, s[8:11], s36 offen offset:3072 lds
    s_mov_b32 s34, 0
    s_cmp_lg_u32 s3, 0
    s_cbranch_scc1 k1_kernel_pl
    v_and_b32 v28, 15, v2
    v_lshlrev_b32 v30, 2, v28
    v_lshlrev_b32 v28, 12, v28
    s_lshl_b32 s52, s23, 8
    s_add_u32 s52, s52, 0x2d00000
k1_kernel_pz0:
    buffer_load_dword v31, v30, s[60:63], 0 offen sc1
    s_add_u32 s34, s34, 1
    s_waitcnt vmcnt(0)
    v_cmp_gt_u32 vcc, 16, v31
    s_cmp_gt_u32 s34, 20000
    s_cbranch_scc1 k1_kernel_pz
    s_cbranch_vccz k1_kernel_pz
    s_sleep 32
    s_branch k1_kernel_pz0
k1_kernel_pz:
    buffer_load_dword v29, v28, s[12:15], s52 offen sc1
    s_add_u32 s34, s34, 1
    s_waitcnt vmcnt(0)
    v_cmp_ne_u32 vcc, 1, v29
    s_cmp_gt_u32 s34, 20000
    s_cbranch_scc1 k1_kernel_pzx
    s_cbranch_vccz k1_kernel_pzx
    s_sleep 8
    s_branch k1_kernel_pz
k1_kernel_pzx:
    v_mov_b32 v27, 1
    ds_write_b32 v26, v27 offset:4
    s_branch k1_kernel_pgo
k1_kernel_pl:
    ds_read_b32 v27, v26 offset:4
    s_add_u32 s34, s34, 1
    s_waitcnt lgkmcnt(0)
    v_readfirstlane_b32 s36, v27
    s_cmp_gt_u32 s34, 400000
    s_cbranch_scc1 k1_kernel_pgo
    s_cmp_lg_u32 s36, 0
    s_cbranch_scc1 k1_kernel_pgo
    s_sleep 2
    s_branch k1_kernel_pl
k1_kernel_pgo:
    s_add_u32 s35, s24, 16384
    s_mov_b32 m0, s35
    s_add_u32 s36, s27, 0
    s_add_u32 s37, s36, s32
    buffer_load_dwordx4 v14, s[12:15], s36 offen offset:0 sc1 lds
    buffer_load_dwordx4 v14, s[12:15], s36 offen offset:1024 sc1 lds
    buffer_load_dwordx4 v14, s[12:15], s36 offen offset:2048 sc1 lds
    buffer_load_dwordx4 v14, s[12:15], s36 offen offset:3072 sc1 lds
    s_add_u32 s35, s35, s32
    s_mov_b32 m0, s35
    s_mov_b64 exec, 0xffffffff
    buffer_load_dwordx4 v14, s[12:15], s37 offen sc1 lds
    s_mov_b64 exec, -1
    s_add_u32 s35, s24, 51200
    s_mov_b32 m0, s35
    s_add_u32 s36, s27, 18432
    s_add_u32 s37, s36, s32
    buffer_load_dwordx4 v14, s[12:15], s36 offen offset:0 sc1 lds
    buffer_load_dwordx4 v14, s[12:15], s36 offen offset:1024 sc1 lds
    buffer_load_dwordx4 v14, s[12:15], s36 offen offset:2048 sc1 lds
    buffer_load_dwordx4 v14, s[12:15], s36 offen offset:3072 sc1 lds
    s_add_u32 s35, s35, s32
    s_mov_b32 m0, s35
    s_mov_b64 exec, 0xffffffff
    buffer_load_dwordx4 v14, s[12:15], s37 offen sc1 lds
    s_mov_b64 exec, -1
    s_add_u32 s35, s24, 86016
    s_mov_b32 m0, s35
    s_add_u32 s36, s27, 36864
    s_add_u32 s37, s36, s32
    buffer_load_dwordx4 v14, s[12:15], s36 offen offset:0 sc1 lds
    buffer_load_dwordx4 v14, s[12:15], s36 offen offset:1024 sc1 lds
    buffer_load_dwordx4 v14, s[12:15], s36 offen offset:2048 sc1 lds
    buffer_load_dwordx4 v14, s[12:15], s36 offen offset:3072 sc1 lds
    s_add_u32 s35, s35, s32
    s_mov_b32 m0, s35
    s_mov_b64 exec, 0xffffffff
    buffer_load_dwordx4 v14, s[12:15], s37 offen sc1 lds
    s_mov_b64 exec, -1
    s_add_u32 s35, s24, 120832
    s_mov_b32 m0, s35
    s_add_u32 s36, s27, 55296
    s_add_u32 s37, s36, s32
    buffer_load_dwordx4 v14, s[12:15], s36 offen offset:0 sc1 lds
    buffer_load_dwordx4 v14, s[12:15], s36 offen offset:1024 sc1 lds
    buffer_load_dwordx4 v14, s[12:15], s36 offen offset:2048 sc1 lds
    buffer_load_dwordx4 v14, s[12:15], s36 offen offset:3072 sc1 lds
    s_add_u32 s35, s35, s32
    s_mov_b32 m0, s35
    s_mov_b64 exec, 0xffffffff
    buffer_load_dwordx4 v14, s[12:15], s37 offen sc1 lds
    s_mov_b64 exec, -1
    s_add_u32 s26, s26, 512
    s_add_u32 s27, s27, 73728
    s_mov_b32 s33, 0
    s_lshl_b32 s43, s2, 2
    s_add_u32 s43, s43, s3
    s_and_b32 s53, s43, 1
    s_sub_u32 s36, s43, 448
    s_lshr_b32 s37, s43, 1
    s_cmp_ge_u32 s43, 896
    s_cselect_b32 s43, s36, s37
    s_cselect_b32 s53, 2, s53
    s_waitcnt vmcnt(15)
    s_barrier
    s_waitcnt vmcnt(10)
    s_barrier
    s_waitcnt vmcnt(5)
    s_barrier
    s_mov_b32 s34, 4
k1_kernel_lloop:
    s_add_u32 s35, s33, s24
    s_mov_b32 m0, s35
    s_add_u32 s36, s35, 16384
    buffer_load_dwordx4 v10, s[8:11], s26 offen offset:0 lds
    buffer_load_dwordx4 v11, s[8:11], s26 offen offset:1024 lds
    buffer_load_dwordx4 v12, s[8:11], s26 offen offset:2048 lds
    buffer_load_dwordx4 v13, s[8:11], s26 offen offset:3072 lds
    s_mov_b32 m0, s36
    s_add_u32 s37, s27, s32
    buffer_load_dwordx4 v14, s[12:15], s27 offen offset:0 sc1 lds
    buffer_load_dwordx4 v14, s[12:15], s27 offen offset:1024 sc1 lds
    buffer_load_dwordx4 v14, s[12:15], s27 offen offset:2048 sc1 lds
    buffer_load_dwordx4 v14, s[12:15], s27 offen offset:3072 sc1 lds
    s_add_u32 s36, s36, s32
    s_mov_b32 m0, s36
    s_mov_b64 exec, 0xffffffff
    buffer_load_dwordx4 v14, s[12:15], s37 offen sc1 lds
    s_mov_b64 exec, -1
    s_add_u32 s26, s26, 128
    s_add_u32 s27, s27, 18432
    s_add_u32 s33, s33, 34816
    s_cmp_eq_u32 s33, 139264
    s_cselect_b32 s33, 0, s33
    s_cmp_eq_u32 s34, 18
    s_cbranch_scc1 k1_kernel_hk1
    s_cmp_eq_u32 s34, 21
    s_cbranch_scc1 k1_kernel_hk2
    s_cmp_eq_u32 s34, 22
    s_cbranch_scc1 k1_kernel_hk2g
k1_kernel_lw9:
    s_waitcnt vmcnt(9)
k1_kernel_lcont:
    s_barrier
    s_add_u32 s34, s34, 1
    s_cmp_lt_u32 s34, 32
    s_cbranch_scc1 k1_kernel_lloop
    s_branch k1_kernel_ldone
k1_kernel_hk1:
    s_cmp_lg_u32 s3, 0
    s_cbranch_scc1 k1_kernel_lw9
    v_lshlrev_b32 v28, 7, v2
    s_mov_b32 s52, 0x2d20000
    buffer_load_dword v32, v28, s[12:15], s52 offen sc1
    s_mov_b32 s52, 0x2d22000
    buffer_load_dword v33, v28, s[12:15], s52 offen sc1
    s_mov_b32 s52, 0x2d24000
    buffer_load_dword v34, v28, s[12:15], s52 offen sc1
    s_mov_b32 s52, 0x2d26000
    buffer_load_dword v35, v28, s[12:15], s52 offen sc1
    s_waitcnt vmcnt(13)
    s_branch k1_kernel_lcont
k1_kernel_hk2:
    s_cmp_lg_u32 s3, 0
    s_cbranch_scc1 k1_kernel_lw9
    s_mov_b32 s52, 0
k1_kernel_hk2l:
    v_and_b32 v32, v32, v33
    v_and_b32 v34, v34, v35
    v_and_b32 v32, v32, v34
    v_cmp_eq_u32 vcc, 1, v32
    s_nop 1
    v_cndmask_b32 v32, 0, 16, vcc
    v_cmp_gt_u32 vcc, 16, v32
    s_add_u32 s52, s52, 1
    s_cmp_gt_u32 s52, 20000
    s_cbranch_scc1 k1_kernel_lw9
    s_cbranch_vccz k1_kernel_lw9
    s_sleep 16
    s_mov_b32 s38, 0x2d20000
    buffer_load_dword v32, v28, s[12:15], s38 offen sc1
    s_mov_b32 s38, 0x2d22000
    buffer_load_dword v33, v28, s[12:15], s38 offen sc1
    s_mov_b32 s38, 0x2d24000
    buffer_load_dword v34, v28, s[12:15], s38 offen sc1
    s_mov_b32 s38, 0x2d26000
    buffer_load_dword v35, v28, s[12:15], s38 offen sc1
    s_waitcnt vmcnt(0)
    s_branch k1_kernel_hk2l
k1_kernel_hk2g:
    s_lshl_b32 s36, s43, 12
    v_lshlrev_b32 v4, 4, v2
    buffer_load_dwordx4 v[56:59], v4, s[16:19], s36 offen offset:0
    buffer_load_dwordx4 v[64:67], v4, s[16:19], s36 offen offset:1024
    buffer_load_dwordx4 v[72:75], v4, s[16:19], s36 offen offset:2048
    buffer_load_dwordx4 v[80:83], v4, s[16:19], s36 offen offset:3072
    v_add_u32 v5, 16, v4
    buffer_load_dword v60, v5, s[16:19], s36 offen offset:0
    buffer_load_dword v68, v5, s[16:19], s36 offen offset:1024
    buffer_load_dword v76, v5, s[16:19], s36 offen offset:2048
    buffer_load_dword v84, v5, s[16:19], s36 offen offset:3072
    s_add_u32 s37, s36, 0x2200000
    buffer_load_dwordx4 v[224:227], v4, s[12:15], s37 offen offset:0 sc1
    buffer_load_dwordx4 v[228:231], v4, s[12:15], s37 offen offset:1024 sc1
    buffer_load_dwordx4 v[232:235], v4, s[12:15], s37 offen offset:2048 sc1
    buffer_load_dwordx4 v[236:239], v4, s[12:15], s37 offen offset:3072 sc1
    s_lshl_b32 s37, s43, 1
    v_mov_b32 v6, s37
    buffer_load_ushort v240, v6, s[84:87], 0 offen
    s_waitcnt vmcnt(22)
    s_branch k1_kernel_lcont
k1_kernel_ldone:
    s_waitcnt vmcnt(0)
    s_barrier
    s_mov_b32 s26, s53
    s_and_b32 s27, s3, 1
    s_mul_i32 s27, s27, 12928
    s_lshr_b32 s36, s3, 1
    s_mul_i32 s36, s36, 34816
    s_add_u32 s27, s27, s36
    s_add_u32 s27, s27, 4096
    v_lshlrev_b32 v4, 4, v2
    v_add_u32 v12, s27, v4
    v_mov_b32 v8, 0
    v_mov_b32 v9, 0
    v_mov_b32 v10, 0
    v_mov_b32 v11, 0
    v_lshlrev_b32 v5, 3, v2
    v_add_u32 v5, s27, v5
    ds_write_b64 v5, v[8:9] offset:12416
    s_mov_b64 exec, 3
    ds_write_b128 v12, v[8:11] offset:0
    ds_write_b128 v12, v[8:11] offset:4160
    s_mov_b64 exec, -1
    ds_write_b128 v12, v[224:227] offset:8320
    ds_write_b128 v12, v[228:231] offset:9344
    ds_write_b128 v12, v[232:235] offset:10368
    ds_write_b128 v12, v[236:239] offset:11392
    s_waitcnt lgkmcnt(3)
    ds_write_b128 v12, v[56:59] offset:32
    v_alignbit_b32 v88, v57, v56, 16
    v_alignbit_b32 v89, v58, v57, 16
    v_alignbit_b32 v90, v59, v58, 16
    v_alignbit_b32 v91, v60, v59, 16
    ds_write_b128 v12, v[88:91] offset:4192
    ds_write_b128 v12, v[64:67] offset:1056
    v_alignbit_b32 v92, v65, v64, 16
    v_alignbit_b32 v93, v66, v65, 16
    v_alignbit_b32 v94, v67, v66, 16
    v_alignbit_b32 v95, v68, v67, 16
    ds_write_b128 v12, v[92:95] offset:5216
    ds_write_b128 v12, v[72:75] offset:2080
    v_alignbit_b32 v88, v73, v72, 16
    v_alignbit_b32 v89, v74, v73, 16
    v_alignbit_b32 v90, v75, v74, 16
    v_alignbit_b32 v91, v76, v75, 16
    ds_write_b128 v12, v[88:91] offset:6240
    ds_write_b128 v12, v[80:83] offset:3104
    v_alignbit_b32 v92, v81, v80, 16
    v_alignbit_b32 v93, v82, v81, 16
    v_alignbit_b32 v94, v83, v82, 16
    v_alignbit_b32 v95, v84, v83, 16
    ds_write_b128 v12, v[92:95] offset:7264
    s_mov_b64 exec, 1
    v_mov_b32 v5, s27
    ds_write_b16 v5, v56 offset:4190
    s_mov_b64 exec, -1
    s_barrier
    s_setprio 0
    v_and_b32 v5, 15, v2
    v_lshrrev_b32 v6, 4, v2
    v_lshl_add_u32 v7, v6, 3, v5
    v_and_b32 v8, 1, v5
    v_add_u32 v7, v7, v8
    v_lshlrev_b32 v7, 1, v7
    v_cmp_eq_u32 vcc, 0, v8
    v_mov_b32 v9, 0
    v_mov_b32 v10, 4160
    v_cndmask_b32 v9, v9, v10, vcc
    v_add3_u32 v7, v7, v9, s27
    v_add_u32 v52, 0, v7
    v_add_u32 v53, 1024, v7
    v_add_u32 v54, 2048, v7
    v_add_u32 v55, 3072, v7
    v_lshlrev_b32 v9, 4, v6
    v_lshlrev_b32 v10, 5, v5
    v_sub_u32 v9, v9, v10
    s_add_u32 s38, s27, 8800
    v_add_u32 v11, s38, v9
    v_lshlrev_b32 v9, 5, v5
    v_lshl_add_u32 v9, v6, 3, v9
    s_add_u32 s38, s27, 8824
    v_sub_u32 v10, s38, v9
    v_mov_b32 v96, 0
    v_mov_b32 v97, 0
    v_mov_b32 v98, 0
    v_mov_b32 v99, 0
    v_mov_b32 v100, 0
    v_mov_b32 v101, 0
    v_mov_b32 v102, 0
    v_mov_b32 v103, 0
    v_mov_b32 v104, 0
    v_mov_b32 v105, 0
    v_mov_b32 v106, 0
    v_mov_b32 v107, 0
    v_mov_b32 v108, 0
    v_mov_b32 v109, 0
    v_mov_b32 v110, 0
    v_mov_b32 v111, 0
    v_lshlrev_b32 v13, 16, v240
    s_lshl_b32 s36, s43, 12
    s_add_u32 s37, s36, 0x2600000
    s_mov_b32 s33, 0
    s_waitcnt lgkmcnt(0)
    s_cmp_eq_u32 s26, 1
    s_cbranch_scc1 k1_kernel_cj1
    ds_read_b128 v[144:147], v11 offset:3584
    ds_read2_b32 v[112:113], v52 offset0:0 offset1:1
    ds_read2_b32 v[114:115], v52 offset0:2 offset1:3
    ds_read_b128 v[148:151], v11 offset:3072
    ds_read2_b32 v[116:117], v52 offset0:128 offset1:129
    ds_read2_b32 v[118:119], v52 offset0:130 offset1:131
    ds_read_b128 v[152:155], v11 offset:2560
    ds_read2_b32 v[120:121], v53 offset0:0 offset1:1
    ds_read2_b32 v[122:123], v53 offset0:2 offset1:3
    ds_read_b128 v[156:159], v11 offset:2048
    ds_read2_b32 v[124:125], v53 offset0:128 offset1:129
    ds_read2_b32 v[126:127], v53 offset0:130 offset1:131
    ds_read_b128 v[160:163], v11 offset:1536
    s_waitcnt lgkmcnt(8)
    ds_read2_b32 v[128:129], v54 offset0:0 offset1:1
    ds_read2_b32 v[130:131], v54 offset0:2 offset1:3
    ds_read_b128 v[164:167], v11 offset:1024
    ds_read2_b32 v[132:133], v54 offset0:128 offset1:129
    ds_read2_b32 v[134:135], v54 offset0:130 offset1:131
    s_waitcnt lgkmcnt(8)
    ds_read_b128 v[168:171], v11 offset:512
    ds_read2_b32 v[136:137], v55 offset0:0 offset1:1
    ds_read2_b32 v[138:139], v55 offset0:2 offset1:3
    ds_read_b128 v[172:175], v11 offset:0
    ds_read2_b32 v[140:141], v55 offset0:128 offset1:129
    s_waitcnt lgkmcnt(8)
    ds_read2_b32 v[142:143], v55 offset0:130 offset1:131
    s_waitcnt lgkmcnt(0)
k1_kernel_cjl0:
    v_mfma_f32_16x16x32_bf16 v[108:111], v[112:115], v[144:147], v[108:111]
    ds_read_b128 v[208:211], v11 offset:3648
    ds_read2_b32 v[176:177], v52 offset0:16 offset1:17
    v_mfma_f32_16x16x32_bf16 v[104:107], v[112:115], v[148:151], v[104:107]
    ds_read2_b32 v[178:179], v52 offset0:18 offset1:19
    v_mfma_f32_16x16x32_bf16 v[104:107], v[116:119], v[144:147], v[104:107]
    ds_read_b128 v[212:215], v11 offset:3136
    ds_read2_b32 v[180:181], v52 offset0:144 offset1:145
    v_mfma_f32_16x16x32_bf16 v[100:103], v[124:127], v[156:159], v[100:103]
    ds_read2_b32 v[182:183], v52 offset0:146 offset1:147
    v_mfma_f32_16x16x32_bf16 v[96:99], v[124:127], v[160:163], v[96:99]
    ds_read_b128 v[216:219], v11 offset:2624
    s_waitcnt lgkmcnt(8)
    ds_read2_b32 v[184:185], v53 offset0:16 offset1:17
    v_mfma_f32_16x16x32_bf16 v[96:99], v[128:131], v[156:159], v[96:99]
    ds_read2_b32 v[186:187], v53 offset0:18 offset1:19
    v_mfma_f32_16x16x32_bf16 v[100:103], v[120:123], v[160:163], v[100:103]
    ds_read_b128 v[220:223], v11 offset:2112
    ds_read2_b32 v[188:189], v53 offset0:144 offset1:145
    v_mfma_f32_16x16x32_bf16 v[100:103], v[128:131], v[152:155], v[100:103]
    ds_read2_b32 v[190:191], v53 offset0:146 offset1:147
    v_mfma_f32_16x16x32_bf16 v[96:99], v[120:123], v[164:167], v[96:99]
    s_waitcnt lgkmcnt(8)
    ds_read_b128 v[224:227], v11 offset:1600
    ds_read2_b32 v[192:193], v54 offset0:16 offset1:17
    v_mfma_f32_16x16x32_bf16 v[96:99], v[132:135], v[152:155], v[96:99]
    ds_read2_b32 v[194:195], v54 offset0:18 offset1:19
    v_mfma_f32_16x16x32_bf16 v[100:103], v[116:119], v[164:167], v[100:103]
    ds_read_b128 v[228:231], v11 offset:1088
    ds_read2_b32 v[196:197], v54 offset0:144 offset1:145
    v_mfma_f32_16x16x32_bf16 v[100:103], v[132:135], v[148:151], v[100:103]
    s_waitcnt lgkmcnt(8)
    ds_read2_b32 v[198:199], v54 offset0:146 offset1:147
    v_mfma_f32_16x16x32_bf16 v[96:99], v[116:119], v[168:171], v[96:99]
    ds_read_b128 v[232:235], v11 offset:576
    ds_read2_b32 v[200:201], v55 offset0:16 offset1:17
    v_mfma_f32_16x16x32_bf16 v[96:99], v[136:139], v[148:151], v[96:99]
    ds_read2_b32 v[202:203], v55 offset0:18 offset1:19
    v_mfma_f32_16x16x32_bf16 v[100:103], v[112:115], v[168:171], v[100:103]
    ds_read_b128 v[236:239], v11 offset:64
    s_waitcnt lgkmcnt(8)
    ds_read2_b32 v[204:205], v55 offset0:144 offset1:145
    v_mfma_f32_16x16x32_bf16 v[100:103], v[136:139], v[144:147], v[100:103]
    ds_read2_b32 v[206:207], v55 offset0:146 offset1:147
    v_mfma_f32_16x16x32_bf16 v[96:99], v[112:115], v[172:175], v[96:99]
    v_mfma_f32_16x16x32_bf16 v[96:99], v[140:143], v[144:147], v[96:99]
    v_mfma_f32_16x16x32_bf16 v[108:111], v[176:179], v[208:211], v[108:111]
    v_add_u32 v11, 128, v11
    v_add_u32 v52, 128, v52
    v_mfma_f32_16x16x32_bf16 v[104:107], v[176:179], v[212:215], v[104:107]
    v_add_u32 v53, 128, v53
    v_add_u32 v54, 128, v54
    v_mfma_f32_16x16x32_bf16 v[104:107], v[180:183], v[208:211], v[104:107]
    v_add_u32 v55, 128, v55
    s_add_u32 s33, s33, 1
    v_mfma_f32_16x16x32_bf16 v[100:103], v[188:191], v[220:223], v[100:103]
    ds_read_b128 v[144:147], v11 offset:3584
    ds_read2_b32 v[112:113], v52 offset0:0 offset1:1
    v_mfma_f32_16x16x32_bf16 v[96:99], v[188:191], v[224:227], v[96:99]
    ds_read2_b32 v[114:115], v52 offset0:2 offset1:3
    s_waitcnt lgkmcnt(8)
    ds_read_b128 v[148:151], v11 offset:3072
    v_mfma_f32_16x16x32_bf16 v[96:99], v[192:195], v[220:223], v[96:99]
    ds_read2_b32 v[116:117], v52 offset0:128 offset1:129
    ds_read2_b32 v[118:119], v52 offset0:130 offset1:131
    v_mfma_f32_16x16x32_bf16 v[100:103], v[184:187], v[224:227], v[100:103]
    ds_read_b128 v[152:155], v11 offset:2560
    ds_read2_b32 v[120:121], v53 offset0:0 offset1:1
    v_mfma_f32_16x16x32_bf16 v[100:103], v[192:195], v[216:219], v[100:103]
    s_waitcnt lgkmcnt(8)
    ds_read2_b32 v[122:123], v53 offset0:2 offset1:3
    v_mfma_f32_16x16x32_bf16 v[96:99], v[184:187], v[228:231], v[96:99]
    ds_read_b128 v[156:159], v11 offset:2048
    ds_read2_b32 v[124:125], v53 offset0:128 offset1:129
    v_mfma_f32_16x16x32_bf16 v[96:99], v[196:199], v[216:219], v[96:99]
    ds_read2_b32 v[126:127], v53 offset0:130 offset1:131
    ds_read_b128 v[160:163], v11 offset:1536
    v_mfma_f32_16x16x32_bf16 v[100:103], v[180:183], v[228:231], v[100:103]
    s_waitcnt lgkmcnt(8)
    ds_read2_b32 v[128:129], v54 offset0:0 offset1:1
    ds_read2_b32 v[130:131], v54 offset0:2 offset1:3
    v_mfma_f32_16x16x32_bf16 v[100:103], v[196:199], v[212:215], v[100:103]
    ds_read_b128 v[164:167], v11 offset:1024
    ds_read2_b32 v[132:133], v54 offset0:128 offset1:129
    v_mfma_f32_16x16x32_bf16 v[96:99], v[180:183], v[232:235], v[96:99]
    ds_read2_b32 v[134:135], v54 offset0:130 offset1:131
    s_waitcnt lgkmcnt(8)
    ds_read_b128 v[168:171], v11 offset:512
    v_mfma_f32_16x16x32_bf16 v[96:99], v[200:203], v[212:215], v[96:99]
    ds_read2_b32 v[136:137], v55 offset0:0 offset1:1
    ds_read2_b32 v[138:139], v55 offset0:2 offset1:3
    v_mfma_f32_16x16x32_bf16 v[100:103], v[176:179], v[232:235], v[100:103]
    ds_read_b128 v[172:175], v11 offset:0
    ds_read2_b32 v[140:141], v55 offset0:128 offset1:129
    v_mfma_f32_16x16x32_bf16 v[100:103], v[200:203], v[208:211], v[100:103]
    s_waitcnt lgkmcnt(8)
    ds_read2_b32 v[142:143], v55 offset0:130 offset1:131
    v_mfma_f32_16x16x32_bf16 v[96:99], v[176:179], v[236:239], v[96:99]
    v_mfma_f32_16x16x32_bf16 v[96:99], v[204:207], v[208:211], v[96:99]
    s_waitcnt lgkmcnt(6)
    s_cmp_lt_u32 s33, 4
    s_cbranch_scc1 k1_kernel_cjl0
    s_waitcnt lgkmcnt(0)
    ds_read_b64 v[112:113], v10 offset:0
    ds_read_b64 v[114:115], v10 offset:512
    ds_read_b64 v[116:117], v10 offset:3072
    ds_read_b64 v[118:119], v10 offset:3584
    s_waitcnt lgkmcnt(0)
    v_and_b32 v120, 0xffff0000, v113
    v_lshlrev_b32 v121, 16, v113
    v_and_b32 v122, 0xffff0000, v112
    v_lshlrev_b32 v123, 16, v112
    v_mul_f32 v120, v120, v13
    v_mul_f32 v121, v121, v13
    v_mul_f32 v122, v122, v13
    v_mul_f32 v123, v123, v13
    v_cvt_pk_bf16_f32 v124, v120, v121
    v_lshlrev_b32 v120, 16, v124
    v_and_b32 v121, 0xffff0000, v124
    v_cvt_pk_bf16_f32 v124, v122, v123
    v_lshlrev_b32 v122, 16, v124
    v_and_b32 v123, 0xffff0000, v124
    v_cvt_pk_bf16_f32 v124, v96, v97
    v_lshlrev_b32 v96, 16, v124
    v_and_b32 v97, 0xffff0000, v124
    v_cvt_pk_bf16_f32 v124, v98, v99
    v_lshlrev_b32 v98, 16, v124
    v_and_b32 v99, 0xffff0000, v124
    v_add_f32 v96, v96, v120
    v_add_f32 v97, v97, v121
    v_add_f32 v98, v98, v122
    v_add_f32 v99, v99, v123
    v_cvt_pk_bf16_f32 v112, v96, v97
    v_cvt_pk_bf16_f32 v113, v98, v99
    buffer_store_dwordx2 v[112:113], v9, s[12:15], s37 offen offset:3584 sc1
    v_and_b32 v120, 0xffff0000, v115
    v_lshlrev_b32 v121, 16, v115
    v_and_b32 v122, 0xffff0000, v114
    v_lshlrev_b32 v123, 16, v114
    v_mul_f32 v120, v120, v13
    v_mul_f32 v121, v121, v13
    v_mul_f32 v122, v122, v13
    v_mul_f32 v123, v123, v13
    v_cvt_pk_bf16_f32 v124, v120, v121
    v_lshlrev_b32 v120, 16, v124
    v_and_b32 v121, 0xffff0000, v124
    v_cvt_pk_bf16_f32 v124, v122, v123
    v_lshlrev_b32 v122, 16, v124
    v_and_b32 v123, 0xffff0000, v124
    v_cvt_pk_bf16_f32 v124, v100, v101
    v_lshlrev_b32 v100, 16, v124
    v_and_b32 v101, 0xffff0000, v124
    v_cvt_pk_bf16_f32 v124, v102, v103
    v_lshlrev_b32 v102, 16, v124
    v_and_b32 v103, 0xffff0000, v124
    v_add_f32 v100, v100, v120
    v_add_f32 v101, v101, v121
    v_add_f32 v102, v102, v122
    v_add_f32 v103, v103, v123
    v_cvt_pk_bf16_f32 v114, v100, v101
    v_cvt_pk_bf16_f32 v115, v102, v103
    buffer_store_dwordx2 v[114:115], v9, s[12:15], s37 offen offset:3072 sc1
    v_and_b32 v120, 0xffff0000, v117
    v_lshlrev_b32 v121, 16, v117
    v_and_b32 v122, 0xffff0000, v116
    v_lshlrev_b32 v123, 16, v116
    v_mul_f32 v120, v120, v13
    v_mul_f32 v121, v121, v13
    v_mul_f32 v122, v122, v13
    v_mul_f32 v123, v123, v13
    v_cvt_pk_bf16_f32 v124, v120, v121
    v_lshlrev_b32 v120, 16, v124
    v_and_b32 v121, 0xffff0000, v124
    v_cvt_pk_bf16_f32 v124, v122, v123
    v_lshlrev_b32 v122, 16, v124
    v_and_b32 v123, 0xffff0000, v124
    v_cvt_pk_bf16_f32 v124, v104, v105
    v_lshlrev_b32 v104, 16, v124
    v_and_b32 v105, 0xffff0000, v124
    v_cvt_pk_bf16_f32 v124, v106, v107
    v_lshlrev_b32 v106, 16, v124
    v_and_b32 v107, 0xffff0000, v124
    v_add_f32 v104, v104, v120
    v_add_f32 v105, v105, v121
    v_add_f32 v106, v106, v122
    v_add_f32 v107, v107, v123
    v_cvt_pk_bf16_f32 v116, v104, v105
    v_cvt_pk_bf16_f32 v117, v106, v107
    buffer_store_dwordx2 v[116:117], v9, s[12:15], s37 offen offset:512 sc1
    v_and_b32 v120, 0xffff0000, v119
    v_lshlrev_b32 v121, 16, v119
    v_and_b32 v122, 0xffff0000, v118
    v_lshlrev_b32 v123, 16, v118
    v_mul_f32 v120, v120, v13
    v_mul_f32 v121, v121, v13
    v_mul_f32 v122, v122, v13
    v_mul_f32 v123, v123, v13
    v_cvt_pk_bf16_f32 v124, v120, v121
    v_lshlrev_b32 v120, 16, v124
    v_and_b32 v121, 0xffff0000, v124
    v_cvt_pk_bf16_f32 v124, v122, v123
    v_lshlrev_b32 v122, 16, v124
    v_and_b32 v123, 0xffff0000, v124
    v_cvt_pk_bf16_f32 v124, v108, v109
    v_lshlrev_b32 v108, 16, v124
    v_and_b32 v109, 0xffff0000, v124
    v_cvt_pk_bf16_f32 v124, v110, v111
    v_lshlrev_b32 v110, 16, v124
    v_and_b32 v111, 0xffff0000, v124
    v_add_f32 v108, v108, v120
    v_add_f32 v109, v109, v121
    v_add_f32 v110, v110, v122
    v_add_f32 v111, v111, v123
    v_cvt_pk_bf16_f32 v118, v108, v109
    v_cvt_pk_bf16_f32 v119, v110, v111
    buffer_store_dwordx2 v[118:119], v9, s[12:15], s37 offen offset:0 sc1
    s_cmp_eq_u32 s26, 0
    s_cbranch_scc1 k1_kernel_cjdone
    v_subrev_u32 v11, 512, v11
    v_subrev_u32 v52, 512, v52
    v_subrev_u32 v53, 512, v53
    v_subrev_u32 v54, 512, v54
    v_subrev_u32 v55, 512, v55
    v_mov_b32 v96, 0
    v_mov_b32 v97, 0
    v_mov_b32 v98, 0
    v_mov_b32 v99, 0
    v_mov_b32 v100, 0
    v_mov_b32 v101, 0
    v_mov_b32 v102, 0
    v_mov_b32 v103, 0
    v_mov_b32 v104, 0
    v_mov_b32 v105, 0
    v_mov_b32 v106, 0
    v_mov_b32 v107, 0
    v_mov_b32 v108, 0
    v_mov_b32 v109, 0
    v_mov_b32 v110, 0
    v_mov_b32 v111, 0
    s_mov_b32 s33, 0
k1_kernel_cj1:
    ds_read_b128 v[144:147], v11 offset:3584
    ds_read2_b32 v[112:113], v52 offset0:0 offset1:1
    ds_read2_b32 v[114:115], v52 offset0:2 offset1:3
    ds_read_b128 v[148:151], v11 offset:3072
    ds_read2_b32 v[116:117], v52 offset0:128 offset1:129
    ds_read2_b32 v[118:119], v52 offset0:130 offset1:131
    ds_read_b128 v[152:155], v11 offset:2560
    ds_read2_b32 v[120:121], v53 offset0:0 offset1:1
    ds_read2_b32 v[122:123], v53 offset0:2 offset1:3
    ds_read_b128 v[156:159], v11 offset:2048
    ds_read2_b32 v[124:125], v53 offset0:128 offset1:129
    ds_read2_b32 v[126:127], v53 offset0:130 offset1:131
    ds_read_b128 v[160:163], v11 offset:1536
    s_waitcnt lgkmcnt(8)
    ds_read2_b32 v[128:129], v54 offset0:0 offset1:1
    ds_read2_b32 v[130:131], v54 offset0:2 offset1:3
    ds_read_b128 v[164:167], v11 offset:1024
    ds_read2_b32 v[132:133], v54 offset0:128 offset1:129
    ds_read2_b32 v[134:135], v54 offset0:130 offset1:131
    s_waitcnt lgkmcnt(0)
k1_kernel_cjl1:
    v_mfma_f32_16x16x32_bf16 v[108:111], v[116:119], v[148:151], v[108:111]
    ds_read_b128 v[208:211], v11 offset:3648
    ds_read2_b32 v[176:177], v52 offset0:16 offset1:17
    v_mfma_f32_16x16x32_bf16 v[100:103], v[120:123], v[152:155], v[100:103]
    ds_read2_b32 v[178:179], v52 offset0:18 offset1:19
    v_mfma_f32_16x16x32_bf16 v[104:107], v[116:119], v[152:155], v[104:107]
    ds_read_b128 v[212:215], v11 offset:3136
    v_mfma_f32_16x16x32_bf16 v[104:107], v[120:123], v[148:151], v[104:107]
    ds_read2_b32 v[180:181], v52 offset0:144 offset1:145
    v_mfma_f32_16x16x32_bf16 v[108:111], v[112:115], v[152:155], v[108:111]
    ds_read2_b32 v[182:183], v52 offset0:146 offset1:147
    v_mfma_f32_16x16x32_bf16 v[108:111], v[120:123], v[144:147], v[108:111]
    ds_read_b128 v[216:219], v11 offset:2624
    v_mfma_f32_16x16x32_bf16 v[96:99], v[120:123], v[156:159], v[96:99]
    s_waitcnt lgkmcnt(8)
    ds_read2_b32 v[184:185], v53 offset0:16 offset1:17
    v_mfma_f32_16x16x32_bf16 v[96:99], v[124:127], v[152:155], v[96:99]
    ds_read2_b32 v[186:187], v53 offset0:18 offset1:19
    v_mfma_f32_16x16x32_bf16 v[100:103], v[116:119], v[156:159], v[100:103]
    ds_read_b128 v[220:223], v11 offset:2112
    ds_read2_b32 v[188:189], v53 offset0:144 offset1:145
    v_mfma_f32_16x16x32_bf16 v[100:103], v[124:127], v[148:151], v[100:103]
    ds_read2_b32 v[190:191], v53 offset0:146 offset1:147
    v_mfma_f32_16x16x32_bf16 v[104:107], v[112:115], v[156:159], v[104:107]
    s_waitcnt lgkmcnt(8)
    ds_read_b128 v[224:227], v11 offset:1600
    v_mfma_f32_16x16x32_bf16 v[104:107], v[124:127], v[144:147], v[104:107]
    ds_read2_b32 v[192:193], v54 offset0:16 offset1:17
    v_mfma_f32_16x16x32_bf16 v[96:99], v[116:119], v[160:163], v[96:99]
    ds_read2_b32 v[194:195], v54 offset0:18 offset1:19
    v_mfma_f32_16x16x32_bf16 v[96:99], v[128:131], v[148:151], v[96:99]
    ds_read_b128 v[228:231], v11 offset:1088
    v_mfma_f32_16x16x32_bf16 v[100:103], v[112:115], v[160:163], v[100:103]
    ds_read2_b32 v[196:197], v54 offset0:144 offset1:145
    v_mfma_f32_16x16x32_bf16 v[100:103], v[128:131], v[144:147], v[100:103]
    s_waitcnt lgkmcnt(8)
    ds_read2_b32 v[198:199], v54 offset0:146 offset1:147
    v_mfma_f32_16x16x32_bf16 v[96:99], v[112:115], v[164:167], v[96:99]
    v_mfma_f32_16x16x32_bf16 v[96:99], v[132:135], v[144:147], v[96:99]
    v_mfma_f32_16x16x32_bf16 v[108:111], v[180:183], v[212:215], v[108:111]
    v_add_u32 v11, 128, v11
    v_add_u32 v52, 128, v52
    v_mfma_f32_16x16x32_bf16 v[100:103], v[184:187], v[216:219], v[100:103]
    v_add_u32 v53, 128, v53
    v_mfma_f32_16x16x32_bf16 v[104:107], v[180:183], v[216:219], v[104:107]
    v_add_u32 v54, 128, v54
    s_add_u32 s33, s33, 1
    v_mfma_f32_16x16x32_bf16 v[104:107], v[184:187], v[212:215], v[104:107]
    ds_read_b128 v[144:147], v11 offset:3584
    v_mfma_f32_16x16x32_bf16 v[108:111], v[176:179], v[216:219], v[108:111]
    ds_read2_b32 v[112:113], v52 offset0:0 offset1:1
    ds_read2_b32 v[114:115], v52 offset0:2 offset1:3
    v_mfma_f32_16x16x32_bf16 v[108:111], v[184:187], v[208:211], v[108:111]
    ds_read_b128 v[148:151], v11 offset:3072
    s_waitcnt lgkmcnt(12)
    v_mfma_f32_16x16x32_bf16 v[96:99], v[184:187], v[220:223], v[96:99]
    ds_read2_b32 v[116:117], v52 offset0:128 offset1:129
    s_waitcnt lgkmcnt(8)
    ds_read2_b32 v[118:119], v52 offset0:130 offset1:131
    v_mfma_f32_16x16x32_bf16 v[96:99], v[188:191], v[216:219], v[96:99]
    ds_read_b128 v[152:155], v11 offset:2560
    v_mfma_f32_16x16x32_bf16 v[100:103], v[180:183], v[220:223], v[100:103]
    ds_read2_b32 v[120:121], v53 offset0:0 offset1:1
    v_mfma_f32_16x16x32_bf16 v[100:103], v[188:191], v[212:215], v[100:103]
    ds_read2_b32 v[122:123], v53 offset0:2 offset1:3
    ds_read_b128 v[156:159], v11 offset:2048
    v_mfma_f32_16x16x32_bf16 v[104:107], v[176:179], v[220:223], v[104:107]
    s_waitcnt lgkmcnt(8)
    ds_read2_b32 v[124:125], v53 offset0:128 offset1:129
    v_mfma_f32_16x16x32_bf16 v[104:107], v[188:191], v[208:211], v[104:107]
    ds_read2_b32 v[126:127], v53 offset0:130 offset1:131
    ds_read_b128 v[160:163], v11 offset:1536
    v_mfma_f32_16x16x32_bf16 v[96:99], v[180:183], v[224:227], v[96:99]
    ds_read2_b32 v[128:129], v54 offset0:0 offset1:1
    v_mfma_f32_16x16x32_bf16 v[96:99], v[192:195], v[212:215], v[96:99]
    ds_read2_b32 v[130:131], v54 offset0:2 offset1:3
    s_waitcnt lgkmcnt(8)
    ds_read_b128 v[164:167], v11 offset:1024
    v_mfma_f32_16x16x32_bf16 v[100:103], v[176:179], v[224:227], v[100:103]
    ds_read2_b32 v[132:133], v54 offset0:128 offset1:129
    v_mfma_f32_16x16x32_bf16 v[100:103], v[192:195], v[208:211], v[100:103]
    ds_read2_b32 v[134:135], v54 offset0:130 offset1:131
    v_mfma_f32_16x16x32_bf16 v[96:99], v[176:179], v[228:231], v[96:99]
    v_mfma_f32_16x16x32_bf16 v[96:99], v[196:199], v[208:211], v[96:99]
    s_waitcnt lgkmcnt(6)
    s_cmp_lt_u32 s33, 4
    s_cbranch_scc1 k1_kernel_cjl1
    s_waitcnt lgkmcnt(0)
    ds_read_b64 v[112:113], v10 offset:1024
    ds_read_b64 v[114:115], v10 offset:1536
    ds_read_b64 v[116:117], v10 offset:2048
    ds_read_b64 v[118:119], v10 offset:2560
    s_waitcnt lgkmcnt(0)
    v_and_b32 v120, 0xffff0000, v113
    v_lshlrev_b32 v121, 16, v113
    v_and_b32 v122, 0xffff0000, v112
    v_lshlrev_b32 v123, 16, v112
    v_mul_f32 v120, v120, v13
    v_mul_f32 v121, v121, v13
    v_mul_f32 v122, v122, v13
    v_mul_f32 v123, v123, v13
    v_cvt_pk_bf16_f32 v124, v120, v121
    v_lshlrev_b32 v120, 16, v124
    v_and_b32 v121, 0xffff0000, v124
    v_cvt_pk_bf16_f32 v124, v122, v123
    v_lshlrev_b32 v122, 16, v124
    v_and_b32 v123, 0xffff0000, v124
    v_cvt_pk_bf16_f32 v124, v96, v97
    v_lshlrev_b32 v96, 16, v124
    v_and_b32 v97, 0xffff0000, v124
    v_cvt_pk_bf16_f32 v124, v98, v99
    v_lshlrev_b32 v98, 16, v124
    v_and_b32 v99, 0xffff0000, v124
    v_add_f32 v96, v96, v120
    v_add_f32 v97, v97, v121
    v_add_f32 v98, v98, v122
    v_add_f32 v99, v99, v123
    v_cvt_pk_bf16_f32 v112, v96, v97
    v_cvt_pk_bf16_f32 v113, v98, v99
    buffer_store_dwordx2 v[112:113], v9, s[12:15], s37 offen offset:2560 sc1
    v_and_b32 v120, 0xffff0000, v115
    v_lshlrev_b32 v121, 16, v115
    v_and_b32 v122, 0xffff0000, v114
    v_lshlrev_b32 v123, 16, v114
    v_mul_f32 v120, v120, v13
    v_mul_f32 v121, v121, v13
    v_mul_f32 v122, v122, v13
    v_mul_f32 v123, v123, v13
    v_cvt_pk_bf16_f32 v124, v120, v121
    v_lshlrev_b32 v120, 16, v124
    v_and_b32 v121, 0xffff0000, v124
    v_cvt_pk_bf16_f32 v124, v122, v123
    v_lshlrev_b32 v122, 16, v124
    v_and_b32 v123, 0xffff0000, v124
    v_cvt_pk_bf16_f32 v124, v100, v101
    v_lshlrev_b32 v100, 16, v124
    v_and_b32 v101, 0xffff0000, v124
    v_cvt_pk_bf16_f32 v124, v102, v103
    v_lshlrev_b32 v102, 16, v124
    v_and_b32 v103, 0xffff0000, v124
    v_add_f32 v100, v100, v120
    v_add_f32 v101, v101, v121
    v_add_f32 v102, v102, v122
    v_add_f32 v103, v103, v123
    v_cvt_pk_bf16_f32 v114, v100, v101
    v_cvt_pk_bf16_f32 v115, v102, v103
    buffer_store_dwordx2 v[114:115], v9, s[12:15], s37 offen offset:2048 sc1
    v_and_b32 v120, 0xffff0000, v117
    v_lshlrev_b32 v121, 16, v117
    v_and_b32 v122, 0xffff0000, v116
    v_lshlrev_b32 v123, 16, v116
    v_mul_f32 v120, v120, v13
    v_mul_f32 v121, v121, v13
    v_mul_f32 v122, v122, v13
    v_mul_f32 v123, v123, v13
    v_cvt_pk_bf16_f32 v124, v120, v121
    v_lshlrev_b32 v120, 16, v124
    v_and_b32 v121, 0xffff0000, v124
    v_cvt_pk_bf16_f32 v124, v122, v123
    v_lshlrev_b32 v122, 16, v124
    v_and_b32 v123, 0xffff0000, v124
    v_cvt_pk_bf16_f32 v124, v104, v105
    v_lshlrev_b32 v104, 16, v124
    v_and_b32 v105, 0xffff0000, v124
    v_cvt_pk_bf16_f32 v124, v106, v107
    v_lshlrev_b32 v106, 16, v124
    v_and_b32 v107, 0xffff0000, v124
    v_add_f32 v104, v104, v120
    v_add_f32 v105, v105, v121
    v_add_f32 v106, v106, v122
    v_add_f32 v107, v107, v123
    v_cvt_pk_bf16_f32 v116, v104, v105
    v_cvt_pk_bf16_f32 v117, v106, v107
    buffer_store_dwordx2 v[116:117], v9, s[12:15], s37 offen offset:1536 sc1
    v_and_b32 v120, 0xffff0000, v119
    v_lshlrev_b32 v121, 16, v119
    v_and_b32 v122, 0xffff0000, v118
    v_lshlrev_b32 v123, 16, v118
    v_mul_f32 v120, v120, v13
    v_mul_f32 v121, v121, v13
    v_mul_f32 v122, v122, v13
    v_mul_f32 v123, v123, v13
    v_cvt_pk_bf16_f32 v124, v120, v121
    v_lshlrev_b32 v120, 16, v124
    v_and_b32 v121, 0xffff0000, v124
    v_cvt_pk_bf16_f32 v124, v122, v123
    v_lshlrev_b32 v122, 16, v124
    v_and_b32 v123, 0xffff0000, v124
    v_cvt_pk_bf16_f32 v124, v108, v109
    v_lshlrev_b32 v108, 16, v124
    v_and_b32 v109, 0xffff0000, v124
    v_cvt_pk_bf16_f32 v124, v110, v111
    v_lshlrev_b32 v110, 16, v124
    v_and_b32 v111, 0xffff0000, v124
    v_add_f32 v108, v108, v120
    v_add_f32 v109, v109, v121
    v_add_f32 v110, v110, v122
    v_add_f32 v111, v111, v123
    v_cvt_pk_bf16_f32 v118, v108, v109
    v_cvt_pk_bf16_f32 v119, v110, v111
    buffer_store_dwordx2 v[118:119], v9, s[12:15], s37 offen offset:1024 sc1
k1_kernel_cjdone:
    s_load_dwordx2 s[4:5], s[0:1], 0
    s_load_dwordx2 s[16:17], s[0:1], 88
    s_and_b32 s20, s2, 7
    s_lshr_b32 s21, s2, 3
    s_and_b32 s22, s20, 3
    s_lshl_b32 s22, s22, 3
    s_and_b32 s23, s21, 7
    s_add_u32 s22, s22, s23
    s_lshr_b32 s23, s20, 2
    s_lshl_b32 s23, s23, 2
    s_lshr_b32 s24, s21, 3
    s_add_u32 s23, s23, s24
    s_lshr_b32 s52, s23, 1
    s_and_b32 s53, s23, 1
    s_lshl_b32 s54, s98, 2
    s_add_u32 s54, s54, s3
    s_waitcnt lgkmcnt(0)
    s_mov_b32 s8, s4
    s_and_b32 s9, s5, 0xffff
    s_mov_b32 s10, 0x240000
    s_mov_b32 s11, 0x00020000
    s_mov_b32 s28, s16
    s_and_b32 s29, s17, 0xffff
    s_mov_b32 s30, 0x240000
    s_mov_b32 s31, 0x00020000
    v_and_b32 v3, 15, v2
    v_lshrrev_b32 v10, 5, v2
    v_lshlrev_b32 v10, 11, v10
    v_bfe_u32 v11, v2, 4, 1
    v_lshl_add_u32 v10, v11, 4, v10
    v_lshl_add_u32 v10, v3, 5, v10
    s_lshl_b32 s26, s3, 12
    v_add_u32 v10, s26, v10
    s_lshl_b32 s26, s53, 10
    v_add_u32 v88, s26, v10
    s_xor_b32 s26, s26, 1024
    v_add_u32 v90, s26, v10
    v_lshrrev_b32 v10, 2, v2
    v_mul_u32_u24 v10, 160, v10
    v_and_b32 v11, 3, v2
    v_lshl_add_u32 v10, v11, 3, v10
    s_mul_i32 s26, s3, 5120
    s_add_u32 s26, s26, 16384
    v_add_u32 v92, s26, v10
    v_add_u32 v93, 128, v92
    v_mov_b32 v26, 2048
    v_mov_b32 v27, 1
    s_waitcnt vmcnt(0)
    s_mov_b64 exec, 1
    ds_add_rtn_u32 v28, v26, v27 offset:20
    s_waitcnt lgkmcnt(0)
    v_readfirstlane_b32 s36, v28
    s_cmp_lg_u32 s36, 3
    s_cbranch_scc1 k1_kernel_nocs
    s_lshl_b32 s36, s2, 7
    s_add_u32 s36, s36, 0x2d30000
    v_mov_b32 v28, 0
    buffer_store_dword v27, v28, s[12:15], s36 offen sc1
k1_kernel_nocs:
    s_mov_b64 exec, -1
    v_and_b32 v3, 15, v2
    v_lshrrev_b32 v10, 4, v2
    v_mul_u32_u24 v13, 1152, v3
    v_lshl_add_u32 v13, v10, 3, v13
    v_lshlrev_b32 v12, 3, v3
    s_add_u32 s36, s54, 0
    s_lshr_b32 s37, s36, 2
    s_and_b32 s38, s36, 3
    s_mul_i32 s39, s53, 160
    s_lshl_b32 s40, s37, 5
    s_add_u32 s39, s39, s40
    s_lshl_b32 s40, s53, 1
    s_add_u32 s38, s38, s40
    s_and_b32 s38, s38, 3
    s_lshl_b32 s40, s22, 2
    s_add_u32 s40, s40, s38
    s_lshl_b32 s40, s40, 4
    s_mul_i32 s64, s40, 1152
    s_add_u32 s64, s64, s39
    s_mul_i32 s39, s52, 288
    s_add_u32 s64, s64, s39
    s_lshl_b32 s65, s37, 11
    s_lshl_b32 s39, s38, 5
    s_add_u32 s65, s65, s39
    s_add_u32 s65, s65, 151552
    s_lshl_b32 s66, s36, 10
    s_add_u32 s66, s66, 77824
    s_lshl_b32 s40, s40, 3
    s_add_u32 s40, s40, 0x2b00000
    buffer_load_dwordx2 v[200:201], v13, s[8:11], s64 offen
    buffer_load_dwordx2 v[208:209], v12, s[12:15], s40 offen sc1
    s_add_u32 s36, s54, 8
    s_lshr_b32 s37, s36, 2
    s_and_b32 s38, s36, 3
    s_mul_i32 s39, s53, 160
    s_lshl_b32 s40, s37, 5
    s_add_u32 s39, s39, s40
    s_lshl_b32 s40, s53, 1
    s_add_u32 s38, s38, s40
    s_and_b32 s38, s38, 3
    s_lshl_b32 s40, s22, 2
    s_add_u32 s40, s40, s38
    s_lshl_b32 s40, s40, 4
    s_mul_i32 s68, s40, 1152
    s_add_u32 s68, s68, s39
    s_mul_i32 s39, s52, 288
    s_add_u32 s68, s68, s39
    s_lshl_b32 s69, s37, 11
    s_lshl_b32 s39, s38, 5
    s_add_u32 s69, s69, s39
    s_add_u32 s69, s69, 151552
    s_lshl_b32 s70, s36, 10
    s_add_u32 s70, s70, 77824
    s_lshl_b32 s40, s40, 3
    s_add_u32 s40, s40, 0x2b00000
    buffer_load_dwordx2 v[202:203], v13, s[8:11], s68 offen
    buffer_load_dwordx2 v[210:211], v12, s[12:15], s40 offen sc1
    s_cmp_ge_u32 s54, 2
    s_cbranch_scc1 k1_kernel_fl1
    s_add_u32 s36, s54, 16
    s_mov_b32 s37, 4
    s_mov_b32 s38, s54
    s_mov_b32 s39, 128
    s_lshl_b32 s40, s53, 1
    s_add_u32 s38, s38, s40
    s_and_b32 s38, s38, 3
    s_lshl_b32 s40, s22, 2
    s_add_u32 s40, s40, s38
    s_lshl_b32 s40, s40, 4
    s_mul_i32 s72, s40, 1152
    s_add_u32 s72, s72, s39
    s_mul_i32 s39, s52, 288
    s_add_u32 s72, s72, s39
    s_lshl_b32 s73, s37, 11
    s_lshl_b32 s39, s38, 5
    s_add_u32 s73, s73, s39
    s_add_u32 s73, s73, 151552
    s_lshl_b32 s74, s36, 10
    s_add_u32 s74, s74, 77824
    s_lshl_b32 s40, s40, 3
    s_add_u32 s40, s40, 0x2b00000
    buffer_load_dwordx2 v[204:205], v13, s[8:11], s72 offen
    buffer_load_dwordx2 v[212:213], v12, s[12:15], s40 offen sc1
k1_kernel_fl1:
    s_mov_b32 s27, 77824
    v_add_u32 v4, s27, v88
    v_add_u32 v8, s27, v92
    v_add_u32 v6, s27, v90
    v_add_u32 v9, s27, v93
    v_mov_b32 v128, 0
    v_mov_b32 v129, 0
    v_mov_b32 v130, 0
    v_mov_b32 v131, 0
    v_mov_b32 v132, 0
    v_mov_b32 v133, 0
    v_mov_b32 v134, 0
    v_mov_b32 v135, 0
    v_mov_b32 v136, 0
    v_mov_b32 v137, 0
    v_mov_b32 v138, 0
    v_mov_b32 v139, 0
    v_mov_b32 v140, 0
    v_mov_b32 v141, 0
    v_mov_b32 v142, 0
    v_mov_b32 v143, 0
    v_mov_b32 v144, 0
    v_mov_b32 v145, 0
    v_mov_b32 v146, 0
    v_mov_b32 v147, 0
    v_mov_b32 v148, 0
    v_mov_b32 v149, 0
    v_mov_b32 v150, 0
    v_mov_b32 v151, 0
    v_mov_b32 v152, 0
    v_mov_b32 v153, 0
    v_mov_b32 v154, 0
    v_mov_b32 v155, 0
    v_mov_b32 v156, 0
    v_mov_b32 v157, 0
    v_mov_b32 v158, 0
    v_mov_b32 v159, 0
    v_mov_b32 v160, 0
    v_mov_b32 v161, 0
    v_mov_b32 v162, 0
    v_mov_b32 v163, 0
    v_mov_b32 v164, 0
    v_mov_b32 v165, 0
    v_mov_b32 v166, 0
    v_mov_b32 v167, 0
    v_mov_b32 v168, 0
    v_mov_b32 v169, 0
    v_mov_b32 v170, 0
    v_mov_b32 v171, 0
    v_mov_b32 v172, 0
    v_mov_b32 v173, 0
    v_mov_b32 v174, 0
    v_mov_b32 v175, 0
    v_mov_b32 v176, 0
    v_mov_b32 v177, 0
    v_mov_b32 v178, 0
    v_mov_b32 v179, 0
    v_mov_b32 v180, 0
    v_mov_b32 v181, 0
    v_mov_b32 v182, 0
    v_mov_b32 v183, 0
    v_mov_b32 v184, 0
    v_mov_b32 v185, 0
    v_mov_b32 v186, 0
    v_mov_b32 v187, 0
    v_mov_b32 v188, 0
    v_mov_b32 v189, 0
    v_mov_b32 v190, 0
    v_mov_b32 v191, 0
    v_mov_b32 v192, 0
    v_mov_b32 v193, 0
    v_mov_b32 v194, 0
    v_mov_b32 v195, 0
    v_mov_b32 v196, 0
    v_mov_b32 v197, 0
    v_mov_b32 v198, 0
    v_mov_b32 v199, 0
    s_mov_b32 s33, 0
    s_barrier
    ds_read_b128 v[16:19], v4 offset:0
    ds_read_b64_tr_b16 v[32:33], v8 offset:0
    ds_read_b64_tr_b16 v[34:35], v8 offset:2560
    ds_read_b128 v[20:23], v4 offset:512
    ds_read_b128 v[24:27], v6 offset:0
    ds_read_b128 v[28:31], v6 offset:512
    ds_read_b64_tr_b16 v[36:37], v8 offset:32
    ds_read_b64_tr_b16 v[38:39], v8 offset:2592
    ds_read_b64_tr_b16 v[40:41], v8 offset:64
    ds_read_b64_tr_b16 v[42:43], v8 offset:2624
    ds_read_b64_tr_b16 v[44:45], v8 offset:96
    ds_read_b64_tr_b16 v[46:47], v8 offset:2656
    ds_read_b64_tr_b16 v[48:49], v9 offset:0
    ds_read_b64_tr_b16 v[50:51], v9 offset:2560
k1_kernel_ccloop:
    s_waitcnt lgkmcnt(0)
    s_barrier
    s_add_u32 s27, s27, 36864
    s_cmp_eq_u32 s27, 151552
    s_cselect_b32 s27, 4096, s27
    v_add_u32 v4, s27, v88
    v_add_u32 v8, s27, v92
    v_add_u32 v6, s27, v90
    v_add_u32 v9, s27, v93
    v_mfma_f32_16x16x32_bf16 v[128:131], v[32:35], v[16:19], v[128:131]
    ds_read_b128 v[52:55], v4 offset:0
    v_mfma_f32_16x16x32_bf16 v[132:135], v[32:35], v[20:23], v[132:135]
    ds_read_b64_tr_b16 v[68:69], v8 offset:0
    v_mfma_f32_16x16x32_bf16 v[136:139], v[32:35], v[24:27], v[136:139]
    ds_read_b64_tr_b16 v[70:71], v8 offset:2560
    v_mfma_f32_16x16x32_bf16 v[140:143], v[32:35], v[28:31], v[140:143]
    ds_read_b128 v[56:59], v4 offset:512
    v_mfma_f32_16x16x32_bf16 v[144:147], v[36:39], v[16:19], v[144:147]
    ds_read_b128 v[60:63], v6 offset:0
    v_mfma_f32_16x16x32_bf16 v[148:151], v[36:39], v[20:23], v[148:151]
    ds_read_b128 v[64:67], v6 offset:512
    v_mfma_f32_16x16x32_bf16 v[152:155], v[36:39], v[24:27], v[152:155]
    ds_read_b64_tr_b16 v[72:73], v8 offset:32
    v_mfma_f32_16x16x32_bf16 v[156:159], v[36:39], v[28:31], v[156:159]
    ds_read_b64_tr_b16 v[74:75], v8 offset:2592
    v_mfma_f32_16x16x32_bf16 v[160:163], v[40:43], v[16:19], v[160:163]
    ds_read_b64_tr_b16 v[76:77], v8 offset:64
    v_mfma_f32_16x16x32_bf16 v[164:167], v[40:43], v[20:23], v[164:167]
    ds_read_b64_tr_b16 v[78:79], v8 offset:2624
    v_mfma_f32_16x16x32_bf16 v[168:171], v[40:43], v[24:27], v[168:171]
    ds_read_b64_tr_b16 v[80:81], v8 offset:96
    v_mfma_f32_16x16x32_bf16 v[172:175], v[40:43], v[28:31], v[172:175]
    ds_read_b64_tr_b16 v[82:83], v8 offset:2656
    v_mfma_f32_16x16x32_bf16 v[176:179], v[44:47], v[16:19], v[176:179]
    ds_read_b64_tr_b16 v[84:85], v9 offset:0
    v_mfma_f32_16x16x32_bf16 v[180:183], v[44:47], v[20:23], v[180:183]
    ds_read_b64_tr_b16 v[86:87], v9 offset:2560
    v_mfma_f32_16x16x32_bf16 v[184:187], v[44:47], v[24:27], v[184:187]
    v_mfma_f32_16x16x32_bf16 v[188:191], v[44:47], v[28:31], v[188:191]
    v_mfma_f32_16x16x32_bf16 v[192:195], v[48:51], v[16:19], v[192:195]
    v_mfma_f32_16x16x32_bf16 v[196:199], v[48:51], v[20:23], v[196:199]
    s_waitcnt lgkmcnt(0)
    s_barrier
    s_add_u32 s27, s27, 36864
    s_cmp_eq_u32 s27, 151552
    s_cselect_b32 s27, 4096, s27
    v_add_u32 v4, s27, v88
    v_add_u32 v8, s27, v92
    v_add_u32 v6, s27, v90
    v_add_u32 v9, s27, v93
    v_mfma_f32_16x16x32_bf16 v[128:131], v[68:71], v[52:55], v[128:131]
    ds_read_b128 v[16:19], v4 offset:0
    v_mfma_f32_16x16x32_bf16 v[132:135], v[68:71], v[56:59], v[132:135]
    ds_read_b64_tr_b16 v[32:33], v8 offset:0
    v_mfma_f32_16x16x32_bf16 v[136:139], v[68:71], v[60:63], v[136:139]
    ds_read_b64_tr_b16 v[34:35], v8 offset:2560
    v_mfma_f32_16x16x32_bf16 v[140:143], v[68:71], v[64:67], v[140:143]
    ds_read_b128 v[20:23], v4 offset:512
    v_mfma_f32_16x16x32_bf16 v[144:147], v[72:75], v[52:55], v[144:147]
    ds_read_b128 v[24:27], v6 offset:0
    v_mfma_f32_16x16x32_bf16 v[148:151], v[72:75], v[56:59], v[148:151]
    ds_read_b128 v[28:31], v6 offset:512
    v_mfma_f32_16x16x32_bf16 v[152:155], v[72:75], v[60:63], v[152:155]
    ds_read_b64_tr_b16 v[36:37], v8 offset:32
    v_mfma_f32_16x16x32_bf16 v[156:159], v[72:75], v[64:67], v[156:159]
    ds_read_b64_tr_b16 v[38:39], v8 offset:2592
    v_mfma_f32_16x16x32_bf16 v[160:163], v[76:79], v[52:55], v[160:163]
    ds_read_b64_tr_b16 v[40:41], v8 offset:64
    v_mfma_f32_16x16x32_bf16 v[164:167], v[76:79], v[56:59], v[164:167]
    ds_read_b64_tr_b16 v[42:43], v8 offset:2624
    v_mfma_f32_16x16x32_bf16 v[168:171], v[76:79], v[60:63], v[168:171]
    ds_read_b64_tr_b16 v[44:45], v8 offset:96
    v_mfma_f32_16x16x32_bf16 v[172:175], v[76:79], v[64:67], v[172:175]
    ds_read_b64_tr_b16 v[46:47], v8 offset:2656
    v_mfma_f32_16x16x32_bf16 v[176:179], v[80:83], v[52:55], v[176:179]
    ds_read_b64_tr_b16 v[48:49], v9 offset:0
    v_mfma_f32_16x16x32_bf16 v[180:183], v[80:83], v[56:59], v[180:183]
    ds_read_b64_tr_b16 v[50:51], v9 offset:2560
    v_mfma_f32_16x16x32_bf16 v[184:187], v[80:83], v[60:63], v[184:187]
    v_mfma_f32_16x16x32_bf16 v[188:191], v[80:83], v[64:67], v[188:191]
    v_mfma_f32_16x16x32_bf16 v[192:195], v[84:87], v[52:55], v[192:195]
    v_mfma_f32_16x16x32_bf16 v[196:199], v[84:87], v[56:59], v[196:199]
    s_add_u32 s33, s33, 1
    s_cmp_lt_u32 s33, 9
    s_cbranch_scc1 k1_kernel_ccloop
    s_waitcnt lgkmcnt(0)
    s_mul_i32 s33, s3, 18432
    s_add_u32 s33, s33, 77824
    v_lshlrev_b32 v10, 4, v2
    v_add_u32 v11, s33, v10
    s_nop 4
    ds_write_b128 v11, v[128:131] offset:0
    ds_write_b128 v11, v[132:135] offset:1024
    ds_write_b128 v11, v[136:139] offset:2048
    ds_write_b128 v11, v[140:143] offset:3072
    ds_write_b128 v11, v[144:147] offset:4096
    ds_write_b128 v11, v[148:151] offset:5120
    ds_write_b128 v11, v[152:155] offset:6144
    ds_write_b128 v11, v[156:159] offset:7168
    s_waitcnt lgkmcnt(4)
    ds_write_b128 v11, v[160:163] offset:8192
    ds_write_b128 v11, v[164:167] offset:9216
    ds_write_b128 v11, v[168:171] offset:10240
    ds_write_b128 v11, v[172:175] offset:11264
    ds_write_b128 v11, v[176:179] offset:12288
    ds_write_b128 v11, v[180:183] offset:13312
    s_waitcnt lgkmcnt(4)
    ds_write_b128 v11, v[184:187] offset:14336
    ds_write_b128 v11, v[188:191] offset:15360
    ds_write_b128 v11, v[192:195] offset:16384
    ds_write_b128 v11, v[196:199] offset:17408
    s_waitcnt lgkmcnt(0) vmcnt(0)
k1_kernel_cfin:
    s_barrier
    v_lshlrev_b32 v10, 4, v2
    v_lshrrev_b32 v11, 2, v2
    v_lshlrev_b32 v11, 7, v11
    v_and_b32 v12, 3, v2
    v_lshl_add_u32 v11, v12, 3, v11
    s_mov_b32 s33, 0xbfb8aa3b
    v_add_u32 v4, s66, v10
    v_add_u32 v5, s65, v11
    ds_read_b128 v[16:19], v4 offset:0
    ds_read_b128 v[20:23], v4 offset:18432
    ds_read_b128 v[24:27], v4 offset:36864
    ds_read_b128 v[28:31], v4 offset:55296
    ds_read_b64_tr_b16 v[64:65], v5
    v_add_u32 v4, s70, v10
    v_add_u32 v5, s69, v11
    ds_read_b128 v[32:35], v4 offset:0
    ds_read_b128 v[36:39], v4 offset:18432
    ds_read_b128 v[40:43], v4 offset:36864
    ds_read_b128 v[44:47], v4 offset:55296
    ds_read_b64_tr_b16 v[66:67], v5
    s_cmp_ge_u32 s54, 2
    s_cbranch_scc1 k1_kernel_rd
    v_add_u32 v4, s74, v10
    v_add_u32 v5, s73, v11
    ds_read_b128 v[48:51], v4 offset:0
    ds_read_b128 v[52:55], v4 offset:18432
    ds_read_b128 v[56:59], v4 offset:36864
    ds_read_b128 v[60:63], v4 offset:55296
    ds_read_b64_tr_b16 v[68:69], v5
k1_kernel_rd:
    s_waitcnt lgkmcnt(5)
    v_pk_add_f32 v[16:17], v[16:17], v[20:21]
    v_pk_add_f32 v[24:25], v[24:25], v[28:29]
    v_pk_add_f32 v[18:19], v[18:19], v[22:23]
    v_pk_add_f32 v[26:27], v[26:27], v[30:31]
    v_pk_add_f32 v[16:17], v[16:17], v[24:25]
    v_pk_add_f32 v[18:19], v[18:19], v[26:27]
    v_cvt_pk_bf16_f32 v124, v16, v17
    v_lshlrev_b32 v16, 16, v124
    v_and_b32 v17, 0xffff0000, v124
    v_cvt_pk_bf16_f32 v125, v18, v19
    v_lshlrev_b32 v18, 16, v125
    v_and_b32 v19, 0xffff0000, v125
    v_mul_f32 v104, s33, v16
    v_mul_f32 v105, s33, v17
    v_mul_f32 v106, s33, v18
    v_mul_f32 v107, s33, v19
    v_exp_f32 v104, v104
    v_exp_f32 v105, v105
    v_exp_f32 v106, v106
    v_exp_f32 v107, v107
    v_lshlrev_b32 v108, 16, v200
    v_and_b32 v109, 0xffff0000, v200
    v_lshlrev_b32 v110, 16, v201
    v_and_b32 v111, 0xffff0000, v201
    v_add_f32 v104, 1.0, v104
    v_add_f32 v105, 1.0, v105
    v_add_f32 v106, 1.0, v106
    v_add_f32 v107, 1.0, v107
    v_rcp_f32 v104, v104
    v_rcp_f32 v105, v105
    v_rcp_f32 v106, v106
    v_rcp_f32 v107, v107
    v_sub_f32 v116, v108, v208
    v_sub_f32 v117, v109, v208
    v_sub_f32 v118, v110, v208
    v_sub_f32 v119, v111, v208
    v_lshlrev_b32 v112, 16, v64
    v_and_b32 v113, 0xffff0000, v64
    v_lshlrev_b32 v114, 16, v65
    v_and_b32 v115, 0xffff0000, v65
    v_mul_f32 v16, v16, v104
    v_mul_f32 v17, v17, v105
    v_mul_f32 v18, v18, v106
    v_mul_f32 v19, v19, v107
    v_cvt_pk_bf16_f32 v124, v116, v117
    v_lshlrev_b32 v116, 16, v124
    v_and_b32 v117, 0xffff0000, v124
    v_cvt_pk_bf16_f32 v125, v118, v119
    v_lshlrev_b32 v118, 16, v125
    v_and_b32 v119, 0xffff0000, v125
    v_cvt_pk_bf16_f32 v126, v16, v17
    v_lshlrev_b32 v16, 16, v126
    v_and_b32 v17, 0xffff0000, v126
    v_cvt_pk_bf16_f32 v127, v18, v19
    v_lshlrev_b32 v18, 16, v127
    v_and_b32 v19, 0xffff0000, v127
    v_mul_f32 v116, v116, v209
    v_mul_f32 v117, v117, v209
    v_mul_f32 v118, v118, v209
    v_mul_f32 v119, v119, v209
    v_cvt_pk_bf16_f32 v124, v116, v117
    v_lshlrev_b32 v116, 16, v124
    v_and_b32 v117, 0xffff0000, v124
    v_cvt_pk_bf16_f32 v125, v118, v119
    v_lshlrev_b32 v118, 16, v125
    v_and_b32 v119, 0xffff0000, v125
    v_mul_f32 v116, v116, v112
    v_mul_f32 v117, v117, v113
    v_mul_f32 v118, v118, v114
    v_mul_f32 v119, v119, v115
    v_cvt_pk_bf16_f32 v124, v116, v117
    v_lshlrev_b32 v116, 16, v124
    v_and_b32 v117, 0xffff0000, v124
    v_cvt_pk_bf16_f32 v125, v118, v119
    v_lshlrev_b32 v118, 16, v125
    v_and_b32 v119, 0xffff0000, v125
    v_mul_f32 v116, v116, v16
    v_mul_f32 v117, v117, v17
    v_mul_f32 v118, v118, v18
    v_mul_f32 v119, v119, v19
    v_cvt_pk_bf16_f32 v124, v116, v117
    v_lshlrev_b32 v116, 16, v124
    v_and_b32 v117, 0xffff0000, v124
    v_cvt_pk_bf16_f32 v125, v118, v119
    v_lshlrev_b32 v118, 16, v125
    v_and_b32 v119, 0xffff0000, v125
    v_add_f32 v116, v116, v108
    v_add_f32 v117, v117, v109
    v_add_f32 v118, v118, v110
    v_add_f32 v119, v119, v111
    v_cvt_pk_bf16_f32 v200, v116, v117
    v_cvt_pk_bf16_f32 v201, v118, v119
    buffer_store_dwordx2 v[200:201], v13, s[28:31], s64 offen
    s_waitcnt lgkmcnt(0)
    v_pk_add_f32 v[32:33], v[32:33], v[36:37]
    v_pk_add_f32 v[40:41], v[40:41], v[44:45]
    v_pk_add_f32 v[34:35], v[34:35], v[38:39]
    v_pk_add_f32 v[42:43], v[42:43], v[46:47]
    v_pk_add_f32 v[32:33], v[32:33], v[40:41]
    v_pk_add_f32 v[34:35], v[34:35], v[42:43]
    v_cvt_pk_bf16_f32 v124, v32, v33
    v_lshlrev_b32 v32, 16, v124
    v_and_b32 v33, 0xffff0000, v124
    v_cvt_pk_bf16_f32 v125, v34, v35
    v_lshlrev_b32 v34, 16, v125
    v_and_b32 v35, 0xffff0000, v125
    v_mul_f32 v104, s33, v32
    v_mul_f32 v105, s33, v33
    v_mul_f32 v106, s33, v34
    v_mul_f32 v107, s33, v35
    v_exp_f32 v104, v104
    v_exp_f32 v105, v105
    v_exp_f32 v106, v106
    v_exp_f32 v107, v107
    v_lshlrev_b32 v108, 16, v202
    v_and_b32 v109, 0xffff0000, v202
    v_lshlrev_b32 v110, 16, v203
    v_and_b32 v111, 0xffff0000, v203
    v_add_f32 v104, 1.0, v104
    v_add_f32 v105, 1.0, v105
    v_add_f32 v106, 1.0, v106
    v_add_f32 v107, 1.0, v107
    v_rcp_f32 v104, v104
    v_rcp_f32 v105, v105
    v_rcp_f32 v106, v106
    v_rcp_f32 v107, v107
    v_sub_f32 v116, v108, v210
    v_sub_f32 v117, v109, v210
    v_sub_f32 v118, v110, v210
    v_sub_f32 v119, v111, v210
    v_lshlrev_b32 v112, 16, v66
    v_and_b32 v113, 0xffff0000, v66
    v_lshlrev_b32 v114, 16, v67
    v_and_b32 v115, 0xffff0000, v67
    v_mul_f32 v32, v32, v104
    v_mul_f32 v33, v33, v105
    v_mul_f32 v34, v34, v106
    v_mul_f32 v35, v35, v107
    v_cvt_pk_bf16_f32 v124, v116, v117
    v_lshlrev_b32 v116, 16, v124
    v_and_b32 v117, 0xffff0000, v124
    v_cvt_pk_bf16_f32 v125, v118, v119
    v_lshlrev_b32 v118, 16, v125
    v_and_b32 v119, 0xffff0000, v125
    v_cvt_pk_bf16_f32 v126, v32, v33
    v_lshlrev_b32 v32, 16, v126
    v_and_b32 v33, 0xffff0000, v126
    v_cvt_pk_bf16_f32 v127, v34, v35
    v_lshlrev_b32 v34, 16, v127
    v_and_b32 v35, 0xffff0000, v127
    v_mul_f32 v116, v116, v211
    v_mul_f32 v117, v117, v211
    v_mul_f32 v118, v118, v211
    v_mul_f32 v119, v119, v211
    v_cvt_pk_bf16_f32 v124, v116, v117
    v_lshlrev_b32 v116, 16, v124
    v_and_b32 v117, 0xffff0000, v124
    v_cvt_pk_bf16_f32 v125, v118, v119
    v_lshlrev_b32 v118, 16, v125
    v_and_b32 v119, 0xffff0000, v125
    v_mul_f32 v116, v116, v112
    v_mul_f32 v117, v117, v113
    v_mul_f32 v118, v118, v114
    v_mul_f32 v119, v119, v115
    v_cvt_pk_bf16_f32 v124, v116, v117
    v_lshlrev_b32 v116, 16, v124
    v_and_b32 v117, 0xffff0000, v124
    v_cvt_pk_bf16_f32 v125, v118, v119
    v_lshlrev_b32 v118, 16, v125
    v_and_b32 v119, 0xffff0000, v125
    v_mul_f32 v116, v116, v32
    v_mul_f32 v117, v117, v33
    v_mul_f32 v118, v118, v34
    v_mul_f32 v119, v119, v35
    v_cvt_pk_bf16_f32 v124, v116, v117
    v_lshlrev_b32 v116, 16, v124
    v_and_b32 v117, 0xffff0000, v124
    v_cvt_pk_bf16_f32 v125, v118, v119
    v_lshlrev_b32 v118, 16, v125
    v_and_b32 v119, 0xffff0000, v125
    v_add_f32 v116, v116, v108
    v_add_f32 v117, v117, v109
    v_add_f32 v118, v118, v110
    v_add_f32 v119, v119, v111
    v_cvt_pk_bf16_f32 v202, v116, v117
    v_cvt_pk_bf16_f32 v203, v118, v119
    buffer_store_dwordx2 v[202:203], v13, s[28:31], s68 offen
    s_cmp_ge_u32 s54, 2
    s_cbranch_scc1 k1_kernel_done
    v_pk_add_f32 v[48:49], v[48:49], v[52:53]
    v_pk_add_f32 v[56:57], v[56:57], v[60:61]
    v_pk_add_f32 v[50:51], v[50:51], v[54:55]
    v_pk_add_f32 v[58:59], v[58:59], v[62:63]
    v_pk_add_f32 v[48:49], v[48:49], v[56:57]
    v_pk_add_f32 v[50:51], v[50:51], v[58:59]
    v_cvt_pk_bf16_f32 v124, v48, v49
    v_lshlrev_b32 v48, 16, v124
    v_and_b32 v49, 0xffff0000, v124
    v_cvt_pk_bf16_f32 v125, v50, v51
    v_lshlrev_b32 v50, 16, v125
    v_and_b32 v51, 0xffff0000, v125
    v_mul_f32 v104, s33, v48
    v_mul_f32 v105, s33, v49
    v_mul_f32 v106, s33, v50
    v_mul_f32 v107, s33, v51
    v_exp_f32 v104, v104
    v_exp_f32 v105, v105
    v_exp_f32 v106, v106
    v_exp_f32 v107, v107
    v_lshlrev_b32 v108, 16, v204
    v_and_b32 v109, 0xffff0000, v204
    v_lshlrev_b32 v110, 16, v205
    v_and_b32 v111, 0xffff0000, v205
    v_add_f32 v104, 1.0, v104
    v_add_f32 v105, 1.0, v105
    v_add_f32 v106, 1.0, v106
    v_add_f32 v107, 1.0, v107
    v_rcp_f32 v104, v104
    v_rcp_f32 v105, v105
    v_rcp_f32 v106, v106
    v_rcp_f32 v107, v107
    v_sub_f32 v116, v108, v212
    v_sub_f32 v117, v109, v212
    v_sub_f32 v118, v110, v212
    v_sub_f32 v119, v111, v212
    v_lshlrev_b32 v112, 16, v68
    v_and_b32 v113, 0xffff0000, v68
    v_lshlrev_b32 v114, 16, v69
    v_and_b32 v115, 0xffff0000, v69
    v_mul_f32 v48, v48, v104
    v_mul_f32 v49, v49, v105
    v_mul_f32 v50, v50, v106
    v_mul_f32 v51, v51, v107
    v_cvt_pk_bf16_f32 v124, v116, v117
    v_lshlrev_b32 v116, 16, v124
    v_and_b32 v117, 0xffff0000, v124
    v_cvt_pk_bf16_f32 v125, v118, v119
    v_lshlrev_b32 v118, 16, v125
    v_and_b32 v119, 0xffff0000, v125
    v_cvt_pk_bf16_f32 v126, v48, v49
    v_lshlrev_b32 v48, 16, v126
    v_and_b32 v49, 0xffff0000, v126
    v_cvt_pk_bf16_f32 v127, v50, v51
    v_lshlrev_b32 v50, 16, v127
    v_and_b32 v51, 0xffff0000, v127
    v_mul_f32 v116, v116, v213
    v_mul_f32 v117, v117, v213
    v_mul_f32 v118, v118, v213
    v_mul_f32 v119, v119, v213
    v_cvt_pk_bf16_f32 v124, v116, v117
    v_lshlrev_b32 v116, 16, v124
    v_and_b32 v117, 0xffff0000, v124
    v_cvt_pk_bf16_f32 v125, v118, v119
    v_lshlrev_b32 v118, 16, v125
    v_and_b32 v119, 0xffff0000, v125
    v_mul_f32 v116, v116, v112
    v_mul_f32 v117, v117, v113
    v_mul_f32 v118, v118, v114
    v_mul_f32 v119, v119, v115
    v_cvt_pk_bf16_f32 v124, v116, v117
    v_lshlrev_b32 v116, 16, v124
    v_and_b32 v117, 0xffff0000, v124
    v_cvt_pk_bf16_f32 v125, v118, v119
    v_lshlrev_b32 v118, 16, v125
    v_and_b32 v119, 0xffff0000, v125
    v_mul_f32 v116, v116, v48
    v_mul_f32 v117, v117, v49
    v_mul_f32 v118, v118, v50
    v_mul_f32 v119, v119, v51
    v_cvt_pk_bf16_f32 v124, v116, v117
    v_lshlrev_b32 v116, 16, v124
    v_and_b32 v117, 0xffff0000, v124
    v_cvt_pk_bf16_f32 v125, v118, v119
    v_lshlrev_b32 v118, 16, v125
    v_and_b32 v119, 0xffff0000, v125
    v_add_f32 v116, v116, v108
    v_add_f32 v117, v117, v109
    v_add_f32 v118, v118, v110
    v_add_f32 v119, v119, v111
    v_cvt_pk_bf16_f32 v204, v116, v117
    v_cvt_pk_bf16_f32 v205, v118, v119
    buffer_store_dwordx2 v[204:205], v13, s[28:31], s72 offen
k1_kernel_done:
k1_kernel_end:
    s_endpgm
k1_kernel_gsub0:
    v_pk_fma_f32 v[128:129], v[216:217], v[100:101], v[128:129] op_sel_hi:[1,0,1]
    v_pk_fma_f32 v[130:131], v[218:219], v[100:101], v[130:131] op_sel_hi:[1,0,1]
    v_pk_fma_f32 v[132:133], v[216:217], v[102:103], v[132:133] op_sel_hi:[1,0,1]
    v_pk_fma_f32 v[134:135], v[218:219], v[102:103], v[134:135] op_sel_hi:[1,0,1]
    v_pk_fma_f32 v[136:137], v[216:217], v[104:105], v[136:137] op_sel_hi:[1,0,1]
    v_pk_fma_f32 v[138:139], v[218:219], v[104:105], v[138:139] op_sel_hi:[1,0,1]
    v_pk_fma_f32 v[140:141], v[216:217], v[106:107], v[140:141] op_sel_hi:[1,0,1]
    v_pk_fma_f32 v[142:143], v[218:219], v[106:107], v[142:143] op_sel_hi:[1,0,1]
    v_pk_mul_f32 v[128:129], v[128:129], v[100:101] op_sel:[0,1] op_sel_hi:[1,1]
    v_pk_mul_f32 v[130:131], v[130:131], v[100:101] op_sel:[0,1] op_sel_hi:[1,1]
    v_pk_mul_f32 v[132:133], v[132:133], v[102:103] op_sel:[0,1] op_sel_hi:[1,1]
    v_pk_mul_f32 v[134:135], v[134:135], v[102:103] op_sel:[0,1] op_sel_hi:[1,1]
    v_pk_mul_f32 v[136:137], v[136:137], v[104:105] op_sel:[0,1] op_sel_hi:[1,1]
    v_pk_mul_f32 v[138:139], v[138:139], v[104:105] op_sel:[0,1] op_sel_hi:[1,1]
    v_pk_mul_f32 v[140:141], v[140:141], v[106:107] op_sel:[0,1] op_sel_hi:[1,1]
    v_pk_mul_f32 v[142:143], v[142:143], v[106:107] op_sel:[0,1] op_sel_hi:[1,1]
    v_pk_mul_f32 v[72:73], v[128:129], v[128:129]
    v_pk_mul_f32 v[74:75], v[130:131], v[130:131]
    v_pk_mul_f32 v[76:77], v[132:133], v[132:133]
    v_pk_mul_f32 v[78:79], v[134:135], v[134:135]
    v_pk_mul_f32 v[80:81], v[136:137], v[136:137]
    v_pk_mul_f32 v[82:83], v[138:139], v[138:139]
    v_pk_mul_f32 v[84:85], v[140:141], v[140:141]
    v_pk_mul_f32 v[86:87], v[142:143], v[142:143]
    v_pk_fma_f32 v[72:73], v[72:73], s[54:55], v[14:15]
    v_pk_fma_f32 v[74:75], v[74:75], s[54:55], v[14:15]
    v_pk_fma_f32 v[76:77], v[76:77], s[54:55], v[14:15]
    v_pk_fma_f32 v[78:79], v[78:79], s[54:55], v[14:15]
    v_pk_fma_f32 v[80:81], v[80:81], s[54:55], v[14:15]
    v_pk_fma_f32 v[82:83], v[82:83], s[54:55], v[14:15]
    v_pk_fma_f32 v[84:85], v[84:85], s[54:55], v[14:15]
    v_pk_fma_f32 v[86:87], v[86:87], s[54:55], v[14:15]
    v_pk_mul_f32 v[72:73], v[72:73], v[128:129]
    v_pk_mul_f32 v[74:75], v[74:75], v[130:131]
    v_pk_mul_f32 v[76:77], v[76:77], v[132:133]
    v_pk_mul_f32 v[78:79], v[78:79], v[134:135]
    v_pk_mul_f32 v[80:81], v[80:81], v[136:137]
    v_pk_mul_f32 v[82:83], v[82:83], v[138:139]
    v_pk_mul_f32 v[84:85], v[84:85], v[140:141]
    v_pk_mul_f32 v[86:87], v[86:87], v[142:143]
    v_exp_f32 v72, v72
    v_exp_f32 v73, v73
    v_exp_f32 v74, v74
    v_exp_f32 v75, v75
    v_exp_f32 v76, v76
    v_exp_f32 v77, v77
    v_exp_f32 v78, v78
    v_exp_f32 v79, v79
    v_exp_f32 v80, v80
    v_exp_f32 v81, v81
    v_exp_f32 v82, v82
    v_exp_f32 v83, v83
    v_exp_f32 v84, v84
    v_exp_f32 v85, v85
    v_exp_f32 v86, v86
    v_exp_f32 v87, v87
    v_pk_add_f32 v[72:73], v[72:73], s[56:57]
    v_pk_add_f32 v[74:75], v[74:75], s[56:57]
    v_pk_add_f32 v[76:77], v[76:77], s[56:57]
    v_pk_add_f32 v[78:79], v[78:79], s[56:57]
    v_pk_add_f32 v[80:81], v[80:81], s[56:57]
    v_pk_add_f32 v[82:83], v[82:83], s[56:57]
    v_pk_add_f32 v[84:85], v[84:85], s[56:57]
    v_pk_add_f32 v[86:87], v[86:87], s[56:57]
    v_rcp_f32 v72, v72
    v_rcp_f32 v73, v73
    v_rcp_f32 v74, v74
    v_rcp_f32 v75, v75
    v_rcp_f32 v76, v76
    v_rcp_f32 v77, v77
    v_rcp_f32 v78, v78
    v_rcp_f32 v79, v79
    v_rcp_f32 v80, v80
    v_rcp_f32 v81, v81
    v_rcp_f32 v82, v82
    v_rcp_f32 v83, v83
    v_rcp_f32 v84, v84
    v_rcp_f32 v85, v85
    v_rcp_f32 v86, v86
    v_rcp_f32 v87, v87
    v_pk_mul_f32 v[72:73], v[72:73], v[128:129]
    v_pk_mul_f32 v[74:75], v[74:75], v[130:131]
    v_pk_mul_f32 v[76:77], v[76:77], v[132:133]
    v_pk_mul_f32 v[78:79], v[78:79], v[134:135]
    v_pk_mul_f32 v[80:81], v[80:81], v[136:137]
    v_pk_mul_f32 v[82:83], v[82:83], v[138:139]
    v_pk_mul_f32 v[84:85], v[84:85], v[140:141]
    v_pk_mul_f32 v[86:87], v[86:87], v[142:143]
    v_cvt_pk_bf16_f32 v16, v72, v73
    v_cvt_pk_bf16_f32 v17, v74, v75
    v_cvt_pk_bf16_f32 v18, v76, v77
    v_cvt_pk_bf16_f32 v19, v78, v79
    v_cvt_pk_bf16_f32 v20, v80, v81
    v_cvt_pk_bf16_f32 v21, v82, v83
    v_cvt_pk_bf16_f32 v22, v84, v85
    v_cvt_pk_bf16_f32 v23, v86, v87
    s_setpc_b64 s[34:35]
k1_kernel_gsub1:
    v_pk_fma_f32 v[144:145], v[220:221], v[100:101], v[144:145] op_sel_hi:[1,0,1]
    v_pk_fma_f32 v[146:147], v[222:223], v[100:101], v[146:147] op_sel_hi:[1,0,1]
    v_pk_fma_f32 v[148:149], v[220:221], v[102:103], v[148:149] op_sel_hi:[1,0,1]
    v_pk_fma_f32 v[150:151], v[222:223], v[102:103], v[150:151] op_sel_hi:[1,0,1]
    v_pk_fma_f32 v[152:153], v[220:221], v[104:105], v[152:153] op_sel_hi:[1,0,1]
    v_pk_fma_f32 v[154:155], v[222:223], v[104:105], v[154:155] op_sel_hi:[1,0,1]
    v_pk_fma_f32 v[156:157], v[220:221], v[106:107], v[156:157] op_sel_hi:[1,0,1]
    v_pk_fma_f32 v[158:159], v[222:223], v[106:107], v[158:159] op_sel_hi:[1,0,1]
    v_pk_mul_f32 v[144:145], v[144:145], v[100:101] op_sel:[0,1] op_sel_hi:[1,1]
    v_pk_mul_f32 v[146:147], v[146:147], v[100:101] op_sel:[0,1] op_sel_hi:[1,1]
    v_pk_mul_f32 v[148:149], v[148:149], v[102:103] op_sel:[0,1] op_sel_hi:[1,1]
    v_pk_mul_f32 v[150:151], v[150:151], v[102:103] op_sel:[0,1] op_sel_hi:[1,1]
    v_pk_mul_f32 v[152:153], v[152:153], v[104:105] op_sel:[0,1] op_sel_hi:[1,1]
    v_pk_mul_f32 v[154:155], v[154:155], v[104:105] op_sel:[0,1] op_sel_hi:[1,1]
    v_pk_mul_f32 v[156:157], v[156:157], v[106:107] op_sel:[0,1] op_sel_hi:[1,1]
    v_pk_mul_f32 v[158:159], v[158:159], v[106:107] op_sel:[0,1] op_sel_hi:[1,1]
    v_pk_mul_f32 v[72:73], v[144:145], v[144:145]
    v_pk_mul_f32 v[74:75], v[146:147], v[146:147]
    v_pk_mul_f32 v[76:77], v[148:149], v[148:149]
    v_pk_mul_f32 v[78:79], v[150:151], v[150:151]
    v_pk_mul_f32 v[80:81], v[152:153], v[152:153]
    v_pk_mul_f32 v[82:83], v[154:155], v[154:155]
    v_pk_mul_f32 v[84:85], v[156:157], v[156:157]
    v_pk_mul_f32 v[86:87], v[158:159], v[158:159]
    v_pk_fma_f32 v[72:73], v[72:73], s[54:55], v[14:15]
    v_pk_fma_f32 v[74:75], v[74:75], s[54:55], v[14:15]
    v_pk_fma_f32 v[76:77], v[76:77], s[54:55], v[14:15]
    v_pk_fma_f32 v[78:79], v[78:79], s[54:55], v[14:15]
    v_pk_fma_f32 v[80:81], v[80:81], s[54:55], v[14:15]
    v_pk_fma_f32 v[82:83], v[82:83], s[54:55], v[14:15]
    v_pk_fma_f32 v[84:85], v[84:85], s[54:55], v[14:15]
    v_pk_fma_f32 v[86:87], v[86:87], s[54:55], v[14:15]
    v_pk_mul_f32 v[72:73], v[72:73], v[144:145]
    v_pk_mul_f32 v[74:75], v[74:75], v[146:147]
    v_pk_mul_f32 v[76:77], v[76:77], v[148:149]
    v_pk_mul_f32 v[78:79], v[78:79], v[150:151]
    v_pk_mul_f32 v[80:81], v[80:81], v[152:153]
    v_pk_mul_f32 v[82:83], v[82:83], v[154:155]
    v_pk_mul_f32 v[84:85], v[84:85], v[156:157]
    v_pk_mul_f32 v[86:87], v[86:87], v[158:159]
    v_exp_f32 v72, v72
    v_exp_f32 v73, v73
    v_exp_f32 v74, v74
    v_exp_f32 v75, v75
    v_exp_f32 v76, v76
    v_exp_f32 v77, v77
    v_exp_f32 v78, v78
    v_exp_f32 v79, v79
    v_exp_f32 v80, v80
    v_exp_f32 v81, v81
    v_exp_f32 v82, v82
    v_exp_f32 v83, v83
    v_exp_f32 v84, v84
    v_exp_f32 v85, v85
    v_exp_f32 v86, v86
    v_exp_f32 v87, v87
    v_pk_add_f32 v[72:73], v[72:73], s[56:57]
    v_pk_add_f32 v[74:75], v[74:75], s[56:57]
    v_pk_add_f32 v[76:77], v[76:77], s[56:57]
    v_pk_add_f32 v[78:79], v[78:79], s[56:57]
    v_pk_add_f32 v[80:81], v[80:81], s[56:57]
    v_pk_add_f32 v[82:83], v[82:83], s[56:57]
    v_pk_add_f32 v[84:85], v[84:85], s[56:57]
    v_pk_add_f32 v[86:87], v[86:87], s[56:57]
    v_rcp_f32 v72, v72
    v_rcp_f32 v73, v73
    v_rcp_f32 v74, v74
    v_rcp_f32 v75, v75
    v_rcp_f32 v76, v76
    v_rcp_f32 v77, v77
    v_rcp_f32 v78, v78
    v_rcp_f32 v79, v79
    v_rcp_f32 v80, v80
    v_rcp_f32 v81, v81
    v_rcp_f32 v82, v82
    v_rcp_f32 v83, v83
    v_rcp_f32 v84, v84
    v_rcp_f32 v85, v85
    v_rcp_f32 v86, v86
    v_rcp_f32 v87, v87
    v_pk_mul_f32 v[72:73], v[72:73], v[144:145]
    v_pk_mul_f32 v[74:75], v[74:75], v[146:147]
    v_pk_mul_f32 v[76:77], v[76:77], v[148:149]
    v_pk_mul_f32 v[78:79], v[78:79], v[150:151]
    v_pk_mul_f32 v[80:81], v[80:81], v[152:153]
    v_pk_mul_f32 v[82:83], v[82:83], v[154:155]
    v_pk_mul_f32 v[84:85], v[84:85], v[156:157]
    v_pk_mul_f32 v[86:87], v[86:87], v[158:159]
    v_cvt_pk_bf16_f32 v24, v72, v73
    v_cvt_pk_bf16_f32 v25, v74, v75
    v_cvt_pk_bf16_f32 v26, v76, v77
    v_cvt_pk_bf16_f32 v27, v78, v79
    v_cvt_pk_bf16_f32 v28, v80, v81
    v_cvt_pk_bf16_f32 v29, v82, v83
    v_cvt_pk_bf16_f32 v30, v84, v85
    v_cvt_pk_bf16_f32 v31, v86, v87
    s_setpc_b64 s[34:35]
k1_kernel_gsub2:
    v_pk_fma_f32 v[160:161], v[224:225], v[100:101], v[160:161] op_sel_hi:[1,0,1]
    v_pk_fma_f32 v[162:163], v[226:227], v[100:101], v[162:163] op_sel_hi:[1,0,1]
    v_pk_fma_f32 v[164:165], v[224:225], v[102:103], v[164:165] op_sel_hi:[1,0,1]
    v_pk_fma_f32 v[166:167], v[226:227], v[102:103], v[166:167] op_sel_hi:[1,0,1]
    v_pk_fma_f32 v[168:169], v[224:225], v[104:105], v[168:169] op_sel_hi:[1,0,1]
    v_pk_fma_f32 v[170:171], v[226:227], v[104:105], v[170:171] op_sel_hi:[1,0,1]
    v_pk_fma_f32 v[172:173], v[224:225], v[106:107], v[172:173] op_sel_hi:[1,0,1]
    v_pk_fma_f32 v[174:175], v[226:227], v[106:107], v[174:175] op_sel_hi:[1,0,1]
    v_pk_mul_f32 v[160:161], v[160:161], v[100:101] op_sel:[0,1] op_sel_hi:[1,1]
    v_pk_mul_f32 v[162:163], v[162:163], v[100:101] op_sel:[0,1] op_sel_hi:[1,1]
    v_pk_mul_f32 v[164:165], v[164:165], v[102:103] op_sel:[0,1] op_sel_hi:[1,1]
    v_pk_mul_f32 v[166:167], v[166:167], v[102:103] op_sel:[0,1] op_sel_hi:[1,1]
    v_pk_mul_f32 v[168:169], v[168:169], v[104:105] op_sel:[0,1] op_sel_hi:[1,1]
    v_pk_mul_f32 v[170:171], v[170:171], v[104:105] op_sel:[0,1] op_sel_hi:[1,1]
    v_pk_mul_f32 v[172:173], v[172:173], v[106:107] op_sel:[0,1] op_sel_hi:[1,1]
    v_pk_mul_f32 v[174:175], v[174:175], v[106:107] op_sel:[0,1] op_sel_hi:[1,1]
    v_pk_mul_f32 v[72:73], v[160:161], v[160:161]
    v_pk_mul_f32 v[74:75], v[162:163], v[162:163]
    v_pk_mul_f32 v[76:77], v[164:165], v[164:165]
    v_pk_mul_f32 v[78:79], v[166:167], v[166:167]
    v_pk_mul_f32 v[80:81], v[168:169], v[168:169]
    v_pk_mul_f32 v[82:83], v[170:171], v[170:171]
    v_pk_mul_f32 v[84:85], v[172:173], v[172:173]
    v_pk_mul_f32 v[86:87], v[174:175], v[174:175]
    v_pk_fma_f32 v[72:73], v[72:73], s[54:55], v[14:15]
    v_pk_fma_f32 v[74:75], v[74:75], s[54:55], v[14:15]
    v_pk_fma_f32 v[76:77], v[76:77], s[54:55], v[14:15]
    v_pk_fma_f32 v[78:79], v[78:79], s[54:55], v[14:15]
    v_pk_fma_f32 v[80:81], v[80:81], s[54:55], v[14:15]
    v_pk_fma_f32 v[82:83], v[82:83], s[54:55], v[14:15]
    v_pk_fma_f32 v[84:85], v[84:85], s[54:55], v[14:15]
    v_pk_fma_f32 v[86:87], v[86:87], s[54:55], v[14:15]
    v_pk_mul_f32 v[72:73], v[72:73], v[160:161]
    v_pk_mul_f32 v[74:75], v[74:75], v[162:163]
    v_pk_mul_f32 v[76:77], v[76:77], v[164:165]
    v_pk_mul_f32 v[78:79], v[78:79], v[166:167]
    v_pk_mul_f32 v[80:81], v[80:81], v[168:169]
    v_pk_mul_f32 v[82:83], v[82:83], v[170:171]
    v_pk_mul_f32 v[84:85], v[84:85], v[172:173]
    v_pk_mul_f32 v[86:87], v[86:87], v[174:175]
    v_exp_f32 v72, v72
    v_exp_f32 v73, v73
    v_exp_f32 v74, v74
    v_exp_f32 v75, v75
    v_exp_f32 v76, v76
    v_exp_f32 v77, v77
    v_exp_f32 v78, v78
    v_exp_f32 v79, v79
    v_exp_f32 v80, v80
    v_exp_f32 v81, v81
    v_exp_f32 v82, v82
    v_exp_f32 v83, v83
    v_exp_f32 v84, v84
    v_exp_f32 v85, v85
    v_exp_f32 v86, v86
    v_exp_f32 v87, v87
    v_pk_add_f32 v[72:73], v[72:73], s[56:57]
    v_pk_add_f32 v[74:75], v[74:75], s[56:57]
    v_pk_add_f32 v[76:77], v[76:77], s[56:57]
    v_pk_add_f32 v[78:79], v[78:79], s[56:57]
    v_pk_add_f32 v[80:81], v[80:81], s[56:57]
    v_pk_add_f32 v[82:83], v[82:83], s[56:57]
    v_pk_add_f32 v[84:85], v[84:85], s[56:57]
    v_pk_add_f32 v[86:87], v[86:87], s[56:57]
    v_rcp_f32 v72, v72
    v_rcp_f32 v73, v73
    v_rcp_f32 v74, v74
    v_rcp_f32 v75, v75
    v_rcp_f32 v76, v76
    v_rcp_f32 v77, v77
    v_rcp_f32 v78, v78
    v_rcp_f32 v79, v79
    v_rcp_f32 v80, v80
    v_rcp_f32 v81, v81
    v_rcp_f32 v82, v82
    v_rcp_f32 v83, v83
    v_rcp_f32 v84, v84
    v_rcp_f32 v85, v85
    v_rcp_f32 v86, v86
    v_rcp_f32 v87, v87
    v_pk_mul_f32 v[72:73], v[72:73], v[160:161]
    v_pk_mul_f32 v[74:75], v[74:75], v[162:163]
    v_pk_mul_f32 v[76:77], v[76:77], v[164:165]
    v_pk_mul_f32 v[78:79], v[78:79], v[166:167]
    v_pk_mul_f32 v[80:81], v[80:81], v[168:169]
    v_pk_mul_f32 v[82:83], v[82:83], v[170:171]
    v_pk_mul_f32 v[84:85], v[84:85], v[172:173]
    v_pk_mul_f32 v[86:87], v[86:87], v[174:175]
    v_cvt_pk_bf16_f32 v32, v72, v73
    v_cvt_pk_bf16_f32 v33, v74, v75
    v_cvt_pk_bf16_f32 v34, v76, v77
    v_cvt_pk_bf16_f32 v35, v78, v79
    v_cvt_pk_bf16_f32 v36, v80, v81
    v_cvt_pk_bf16_f32 v37, v82, v83
    v_cvt_pk_bf16_f32 v38, v84, v85
    v_cvt_pk_bf16_f32 v39, v86, v87
    s_setpc_b64 s[34:35]
k1_kernel_gsub3:
    v_pk_fma_f32 v[176:177], v[228:229], v[100:101], v[176:177] op_sel_hi:[1,0,1]
    v_pk_fma_f32 v[178:179], v[230:231], v[100:101], v[178:179] op_sel_hi:[1,0,1]
    v_pk_fma_f32 v[180:181], v[228:229], v[102:103], v[180:181] op_sel_hi:[1,0,1]
    v_pk_fma_f32 v[182:183], v[230:231], v[102:103], v[182:183] op_sel_hi:[1,0,1]
    v_pk_fma_f32 v[184:185], v[228:229], v[104:105], v[184:185] op_sel_hi:[1,0,1]
    v_pk_fma_f32 v[186:187], v[230:231], v[104:105], v[186:187] op_sel_hi:[1,0,1]
    v_pk_fma_f32 v[188:189], v[228:229], v[106:107], v[188:189] op_sel_hi:[1,0,1]
    v_pk_fma_f32 v[190:191], v[230:231], v[106:107], v[190:191] op_sel_hi:[1,0,1]
    v_pk_mul_f32 v[176:177], v[176:177], v[100:101] op_sel:[0,1] op_sel_hi:[1,1]
    v_pk_mul_f32 v[178:179], v[178:179], v[100:101] op_sel:[0,1] op_sel_hi:[1,1]
    v_pk_mul_f32 v[180:181], v[180:181], v[102:103] op_sel:[0,1] op_sel_hi:[1,1]
    v_pk_mul_f32 v[182:183], v[182:183], v[102:103] op_sel:[0,1] op_sel_hi:[1,1]
    v_pk_mul_f32 v[184:185], v[184:185], v[104:105] op_sel:[0,1] op_sel_hi:[1,1]
    v_pk_mul_f32 v[186:187], v[186:187], v[104:105] op_sel:[0,1] op_sel_hi:[1,1]
    v_pk_mul_f32 v[188:189], v[188:189], v[106:107] op_sel:[0,1] op_sel_hi:[1,1]
    v_pk_mul_f32 v[190:191], v[190:191], v[106:107] op_sel:[0,1] op_sel_hi:[1,1]
    v_pk_mul_f32 v[72:73], v[176:177], v[176:177]
    v_pk_mul_f32 v[74:75], v[178:179], v[178:179]
    v_pk_mul_f32 v[76:77], v[180:181], v[180:181]
    v_pk_mul_f32 v[78:79], v[182:183], v[182:183]
    v_pk_mul_f32 v[80:81], v[184:185], v[184:185]
    v_pk_mul_f32 v[82:83], v[186:187], v[186:187]
    v_pk_mul_f32 v[84:85], v[188:189], v[188:189]
    v_pk_mul_f32 v[86:87], v[190:191], v[190:191]
    v_pk_fma_f32 v[72:73], v[72:73], s[54:55], v[14:15]
    v_pk_fma_f32 v[74:75], v[74:75], s[54:55], v[14:15]
    v_pk_fma_f32 v[76:77], v[76:77], s[54:55], v[14:15]
    v_pk_fma_f32 v[78:79], v[78:79], s[54:55], v[14:15]
    v_pk_fma_f32 v[80:81], v[80:81], s[54:55], v[14:15]
    v_pk_fma_f32 v[82:83], v[82:83], s[54:55], v[14:15]
    v_pk_fma_f32 v[84:85], v[84:85], s[54:55], v[14:15]
    v_pk_fma_f32 v[86:87], v[86:87], s[54:55], v[14:15]
    v_pk_mul_f32 v[72:73], v[72:73], v[176:177]
    v_pk_mul_f32 v[74:75], v[74:75], v[178:179]
    v_pk_mul_f32 v[76:77], v[76:77], v[180:181]
    v_pk_mul_f32 v[78:79], v[78:79], v[182:183]
    v_pk_mul_f32 v[80:81], v[80:81], v[184:185]
    v_pk_mul_f32 v[82:83], v[82:83], v[186:187]
    v_pk_mul_f32 v[84:85], v[84:85], v[188:189]
    v_pk_mul_f32 v[86:87], v[86:87], v[190:191]
    v_exp_f32 v72, v72
    v_exp_f32 v73, v73
    v_exp_f32 v74, v74
    v_exp_f32 v75, v75
    v_exp_f32 v76, v76
    v_exp_f32 v77, v77
    v_exp_f32 v78, v78
    v_exp_f32 v79, v79
    v_exp_f32 v80, v80
    v_exp_f32 v81, v81
    v_exp_f32 v82, v82
    v_exp_f32 v83, v83
    v_exp_f32 v84, v84
    v_exp_f32 v85, v85
    v_exp_f32 v86, v86
    v_exp_f32 v87, v87
    v_pk_add_f32 v[72:73], v[72:73], s[56:57]
    v_pk_add_f32 v[74:75], v[74:75], s[56:57]
    v_pk_add_f32 v[76:77], v[76:77], s[56:57]
    v_pk_add_f32 v[78:79], v[78:79], s[56:57]
    v_pk_add_f32 v[80:81], v[80:81], s[56:57]
    v_pk_add_f32 v[82:83], v[82:83], s[56:57]
    v_pk_add_f32 v[84:85], v[84:85], s[56:57]
    v_pk_add_f32 v[86:87], v[86:87], s[56:57]
    v_rcp_f32 v72, v72
    v_rcp_f32 v73, v73
    v_rcp_f32 v74, v74
    v_rcp_f32 v75, v75
    v_rcp_f32 v76, v76
    v_rcp_f32 v77, v77
    v_rcp_f32 v78, v78
    v_rcp_f32 v79, v79
    v_rcp_f32 v80, v80
    v_rcp_f32 v81, v81
    v_rcp_f32 v82, v82
    v_rcp_f32 v83, v83
    v_rcp_f32 v84, v84
    v_rcp_f32 v85, v85
    v_rcp_f32 v86, v86
    v_rcp_f32 v87, v87
    v_pk_mul_f32 v[72:73], v[72:73], v[176:177]
    v_pk_mul_f32 v[74:75], v[74:75], v[178:179]
    v_pk_mul_f32 v[76:77], v[76:77], v[180:181]
    v_pk_mul_f32 v[78:79], v[78:79], v[182:183]
    v_pk_mul_f32 v[80:81], v[80:81], v[184:185]
    v_pk_mul_f32 v[82:83], v[82:83], v[186:187]
    v_pk_mul_f32 v[84:85], v[84:85], v[188:189]
    v_pk_mul_f32 v[86:87], v[86:87], v[190:191]
    v_cvt_pk_bf16_f32 v40, v72, v73
    v_cvt_pk_bf16_f32 v41, v74, v75
    v_cvt_pk_bf16_f32 v42, v76, v77
    v_cvt_pk_bf16_f32 v43, v78, v79
    v_cvt_pk_bf16_f32 v44, v80, v81
    v_cvt_pk_bf16_f32 v45, v82, v83
    v_cvt_pk_bf16_f32 v46, v84, v85
    v_cvt_pk_bf16_f32 v47, v86, v87
    s_setpc_b64 s[34:35]
k1_kernel_gsub4:
    v_pk_fma_f32 v[192:193], v[232:233], v[100:101], v[192:193] op_sel_hi:[1,0,1]
    v_pk_fma_f32 v[194:195], v[234:235], v[100:101], v[194:195] op_sel_hi:[1,0,1]
    v_pk_fma_f32 v[196:197], v[232:233], v[102:103], v[196:197] op_sel_hi:[1,0,1]
    v_pk_fma_f32 v[198:199], v[234:235], v[102:103], v[198:199] op_sel_hi:[1,0,1]
    v_pk_mul_f32 v[192:193], v[192:193], v[100:101] op_sel:[0,1] op_sel_hi:[1,1]
    v_pk_mul_f32 v[194:195], v[194:195], v[100:101] op_sel:[0,1] op_sel_hi:[1,1]
    v_pk_mul_f32 v[196:197], v[196:197], v[102:103] op_sel:[0,1] op_sel_hi:[1,1]
    v_pk_mul_f32 v[198:199], v[198:199], v[102:103] op_sel:[0,1] op_sel_hi:[1,1]
    v_pk_mul_f32 v[72:73], v[192:193], v[192:193]
    v_pk_mul_f32 v[74:75], v[194:195], v[194:195]
    v_pk_mul_f32 v[76:77], v[196:197], v[196:197]
    v_pk_mul_f32 v[78:79], v[198:199], v[198:199]
    v_pk_fma_f32 v[72:73], v[72:73], s[54:55], v[14:15]
    v_pk_fma_f32 v[74:75], v[74:75], s[54:55], v[14:15]
    v_pk_fma_f32 v[76:77], v[76:77], s[54:55], v[14:15]
    v_pk_fma_f32 v[78:79], v[78:79], s[54:55], v[14:15]
    v_pk_mul_f32 v[72:73], v[72:73], v[192:193]
    v_pk_mul_f32 v[74:75], v[74:75], v[194:195]
    v_pk_mul_f32 v[76:77], v[76:77], v[196:197]
    v_pk_mul_f32 v[78:79], v[78:79], v[198:199]
    v_exp_f32 v72, v72
    v_exp_f32 v73, v73
    v_exp_f32 v74, v74
    v_exp_f32 v75, v75
    v_exp_f32 v76, v76
    v_exp_f32 v77, v77
    v_exp_f32 v78, v78
    v_exp_f32 v79, v79
    v_pk_add_f32 v[72:73], v[72:73], s[56:57]
    v_pk_add_f32 v[74:75], v[74:75], s[56:57]
    v_pk_add_f32 v[76:77], v[76:77], s[56:57]
    v_pk_add_f32 v[78:79], v[78:79], s[56:57]
    v_rcp_f32 v72, v72
    v_rcp_f32 v73, v73
    v_rcp_f32 v74, v74
    v_rcp_f32 v75, v75
    v_rcp_f32 v76, v76
    v_rcp_f32 v77, v77
    v_rcp_f32 v78, v78
    v_rcp_f32 v79, v79
    v_pk_mul_f32 v[72:73], v[72:73], v[192:193]
    v_pk_mul_f32 v[74:75], v[74:75], v[194:195]
    v_pk_mul_f32 v[76:77], v[76:77], v[196:197]
    v_pk_mul_f32 v[78:79], v[78:79], v[198:199]
    v_cvt_pk_bf16_f32 v48, v72, v73
    v_cvt_pk_bf16_f32 v49, v74, v75
    v_cvt_pk_bf16_f32 v50, v76, v77
    v_cvt_pk_bf16_f32 v51, v78, v79
    s_setpc_b64 s[34:35]
code_end_lbl:
.section .rodata,"a"
.p2align 6
.amdhsa_kernel k1_kernel
  .amdhsa_next_free_vgpr 256
  .amdhsa_next_free_sgpr 102
  .amdhsa_accum_offset 256
  .amdhsa_group_segment_fixed_size 0
  .amdhsa_kernarg_size 112
  .amdhsa_user_sgpr_count 2
  .amdhsa_user_sgpr_kernarg_segment_ptr 1
  .amdhsa_system_sgpr_workgroup_id_x 1
.end_amdhsa_kernel
```
